```python
import torch

def _softmax(x, axis=-1):
    return torch.softmax(x, dim=axis)
def _gelu(x):
    return torch.nn.functional.gelu(x, approximate="tanh")
def _silu(x):
    return torch.nn.functional.silu(x)
def _sigmoid(x):
    return torch.sigmoid(x)
def _layernorm(x, axis=-1, eps=1e-5):
    m = x.mean(dim=axis, keepdim=True)
    v = x.var(dim=axis, keepdim=True, unbiased=False)
    return (x - m) / torch.sqrt(v + eps)
def _scatter_add(tgt, idx, src, axis=0):
    return tgt.clone().index_add_(axis, idx, src)
def _segment_sum(src, seg, n):
    out = torch.zeros((n,) + src.shape[1:], dtype=src.dtype)
    return out.index_add_(0, seg, src)
def _pad(x, pw):
    flat = tuple(v for pair in reversed(pw) for v in pair)
    return torch.nn.functional.pad(x, flat)

kernel_name = 'gated_mix__mha_block__glu_gated_bilinear__prompt'

def setup_inputs():

    _w = (lambda a: (lambda t: t.to(torch.bfloat16) if t.is_floating_point() else t)(torch.as_tensor(a)))
    def _A_setup():
        B, S, D, H = 1, 2048, 512, 32
        return {
            "x": _w((lambda *s: torch.randn(*s, dtype=torch.bfloat16) * 0.05)(B, S, D)),
            "wqkv": _w((lambda *s: torch.randn(*s, dtype=torch.bfloat16) * 0.8)(D, 3 * D)),
            "wo": _w((lambda *s: torch.randn(*s, dtype=torch.bfloat16) * 0.05)(D, D)),
        }
    _A_in = _A_setup()

    def _B_setup():
        B, S, D, F = 1, 2048, 512, 1792
        return {
            "x": _w((lambda *s: torch.randn(*s, dtype=torch.bfloat16) * 0.05)(B, S, D)),
            "w_gate": _w((lambda *s: torch.randn(*s, dtype=torch.bfloat16) * 1.6)(D, F) * (D ** -0.5)),
            "w_up": _w((lambda *s: torch.randn(*s, dtype=torch.bfloat16) * 1.6)(D, F) * (D ** -0.5)),
            "w_down": _w((lambda *s: torch.randn(*s, dtype=torch.bfloat16) * 1.6)(F, D) * (F ** -0.5)),
        }
    _B_in = _B_setup()

    return {
        "A_x": _A_in["x"],
        "A_wqkv": _A_in["wqkv"],
        "A_wo": _A_in["wo"],
        "B_x": _B_in["x"],
        "B_w_gate": _B_in["w_gate"],
        "B_w_up": _B_in["w_up"],
        "B_w_down": _B_in["w_down"],
        "gate_w": _w((lambda *s: torch.randn(*s, dtype=torch.bfloat16) * 0.05)(512) * 16.0),
    }

def reference(A_x, A_wqkv, A_wo, B_x, B_w_gate, B_w_up, B_w_down, gate_w):
    def _A_ref(x, wqkv, wo):
        B, S, D = x.shape
        H = 32
        Dh = D // H
        qkv = (lambda x, *d: x.permute(*d))((x @ wqkv).reshape(B, S, 3, H, Dh), 2, 0, 3, 1, 4)
        q, k, v = qkv[0], qkv[1], qkv[2]
        scores = torch.einsum("bhqd,bhkd->bhqk", q, k) * (Dh ** -0.5)
        p = _softmax(scores, axis=-1)
        o = torch.einsum("bhqk,bhkd->bhqd", p, v)
        return (lambda x, *d: x.permute(*d))(o, 0, 2, 1, 3).reshape(B, S, D) @ wo

    def _B_ref(x, w_gate, w_up, w_down):
        g = torch.einsum("bsd,df->bsf", x, w_gate)
        u = torch.einsum("bsd,df->bsf", x, w_up)
        h = g * u
        return torch.einsum("bsf,fd->bsd", h, w_down)

    x = A_x
    g = _sigmoid((x * gate_w).sum(-1, keepdims=True))
    a = _A_ref(x, A_wqkv, A_wo)
    b = _B_ref(x, B_w_gate, B_w_up, B_w_down)
    return g * a + (1 - g) * b
```

```asm
; @launch kernel=kf_kernel grid=(256,1,1) block=(768,1,1) lds=163840
.amdgcn_target "amdgcn-amd-amdhsa--gfx950"
.text
.globl kf_kernel
.p2align 8
.type kf_kernel,@function
kf_kernel:
    s_cmp_ge_u32 s2, 0x100
    s_cbranch_scc1 KF_END
    s_load_dwordx4 s[4:7], s[0:1], 0
    s_load_dwordx2 s[14:15], s[0:1], 80
    s_load_dwordx8 s[88:95], s[0:1], 32
    s_memrealtime s[56:57]
    s_mov_b32 s96, 0
    s_mov_b32 s97, s2
    s_mov_b64 s[98:99], -1
    s_getpc_b64 s[8:9]
    v_lshlrev_b32 v166, 7, v0
    s_and_b32 s8, s8, 0xffffff00
    s_and_b32 s9, s9, 0xffff
    s_mov_b32 s10, KF_LAST-kf_kernel
    s_mov_b32 s11, 0x00020000
    buffer_load_dword v166, v166, s[8:11], 0 offen
KF_RE:
    v_lshrrev_b32 v1, 6, v0
    v_and_b32 v2, 63, v0
    v_readfirstlane_b32 s3, v1
    s_mov_b32 s60, 0
    s_and_b32 s32, s2, 7
    s_lshr_b32 s33, s2, 3
    s_lshr_b32 s34, s32, 1
    s_lshl_b32 s34, s34, 2
    s_and_b32 s35, s33, 3
    s_add_u32 s34, s34, s35
    s_and_b32 s35, s32, 1
    s_lshl_b32 s35, s35, 3
    s_lshr_b32 s36, s33, 2
    s_add_u32 s35, s35, s36
    v_lshlrev_b32 v1, 4, v2
    s_and_b32 s46, s34, 1
    s_cmp_ge_u32 s3, 8
    s_cbranch_scc0 KF_CMP
KF_GEMM:
    s_setprio 3
    s_sub_u32 s3, s3, 8
    v_lshrrev_b32 v6, 3, v2
    v_and_b32 v7, 7, v2
    v_bfe_u32 v8, v2, 4, 1
    v_lshlrev_b32 v8, 2, v8
    v_xor_b32 v7, v7, v8
    v_mul_u32_u24 v3, 0xc00, v6
    v_lshl_add_u32 v3, v7, 4, v3
    s_lshl_b32 s44, s3, 12
    s_mul_i32 s42, s3, 98304
    s_lshr_b32 s40, s34, 1
    s_lshl_b32 s40, s40, 7
    s_add_u32 s42, s42, s40
    s_lshl_b32 s40, s46, 10
    s_add_u32 s40, s40, s42
    s_add_u32 s40, s40, 1024
    v_lshlrev_b32 v8, 10, v6
    v_and_b32 v9, 7, v2
    v_lshrrev_b32 v10, 4, v2
    v_xor_b32 v9, v9, v10
    v_lshl_add_u32 v20, v9, 4, v8
    v_xor_b32 v21, 64, v20
    v_add_u32 v21, 0x2000, v21
    s_lshl_b32 s47, s35, 17
    s_lshl_b32 s41, s3, 15
    s_add_u32 s47, s47, s41
    s_waitcnt lgkmcnt(0)
    s_mov_b64 s[100:101], s[56:57]
    s_mov_b32 s20, s4
    s_and_b32 s21, s5, 0xffff
    s_mov_b32 s22, 0x200000
    s_mov_b32 s23, 0x00020000
    s_mov_b32 s24, s6
    s_and_b32 s25, s7, 0xffff
    s_mov_b32 s26, 0x180000
    s_mov_b32 s27, 0x00020000
    s_cmp_lg_u32 s46, 0
    s_cbranch_scc0 KF_G0
    s_add_u32 m0, s44, 98304
    s_add_u32 s41, s40, 0
    buffer_load_dwordx4 v3, s[24:27], s41 offen lds
    s_add_u32 m0, s44, 99328
    s_add_u32 s41, s40, 24576
    buffer_load_dwordx4 v3, s[24:27], s41 offen lds
    s_add_u32 m0, s44, 100352
    s_add_u32 s41, s40, 49152
    buffer_load_dwordx4 v3, s[24:27], s41 offen lds
    s_add_u32 m0, s44, 101376
    s_add_u32 s41, s40, 73728
    buffer_load_dwordx4 v3, s[24:27], s41 offen lds
    s_add_u32 m0, s44, 0
    s_add_u32 s41, s47, 0
    buffer_load_dwordx4 v20, s[20:23], s41 offen lds
    s_add_u32 m0, s44, 1024
    s_add_u32 s41, s47, 0
    buffer_load_dwordx4 v21, s[20:23], s41 offen lds
    s_add_u32 m0, s44, 2048
    s_add_u32 s41, s47, 16384
    buffer_load_dwordx4 v20, s[20:23], s41 offen lds
    s_add_u32 m0, s44, 3072
    s_add_u32 s41, s47, 16384
    buffer_load_dwordx4 v21, s[20:23], s41 offen lds
    s_add_u32 m0, s44, 16384
    s_add_u32 s41, s47, 128
    buffer_load_dwordx4 v20, s[20:23], s41 offen lds
    s_add_u32 m0, s44, 17408
    s_add_u32 s41, s47, 128
    buffer_load_dwordx4 v21, s[20:23], s41 offen lds
    s_add_u32 m0, s44, 18432
    s_add_u32 s41, s47, 16512
    buffer_load_dwordx4 v20, s[20:23], s41 offen lds
    s_add_u32 m0, s44, 19456
    s_add_u32 s41, s47, 16512
    buffer_load_dwordx4 v21, s[20:23], s41 offen lds
    s_add_u32 m0, s44, 114688
    s_add_u32 s41, s40, 393216
    buffer_load_dwordx4 v3, s[24:27], s41 offen lds
    s_add_u32 m0, s44, 115712
    s_add_u32 s41, s40, 417792
    buffer_load_dwordx4 v3, s[24:27], s41 offen lds
    s_add_u32 m0, s44, 116736
    s_add_u32 s41, s40, 442368
    buffer_load_dwordx4 v3, s[24:27], s41 offen lds
    s_add_u32 m0, s44, 117760
    s_add_u32 s41, s40, 466944
    buffer_load_dwordx4 v3, s[24:27], s41 offen lds
    s_add_u32 m0, s44, 65536
    s_add_u32 s41, s47, 256
    buffer_load_dwordx4 v20, s[20:23], s41 offen lds
    s_add_u32 m0, s44, 66560
    s_add_u32 s41, s47, 256
    buffer_load_dwordx4 v21, s[20:23], s41 offen lds
    s_add_u32 m0, s44, 67584
    s_add_u32 s41, s47, 16640
    buffer_load_dwordx4 v20, s[20:23], s41 offen lds
    s_add_u32 m0, s44, 68608
    s_add_u32 s41, s47, 16640
    buffer_load_dwordx4 v21, s[20:23], s41 offen lds
    s_add_u32 m0, s44, 81920
    s_add_u32 s41, s47, 384
    buffer_load_dwordx4 v20, s[20:23], s41 offen lds
    s_add_u32 m0, s44, 82944
    s_add_u32 s41, s47, 384
    buffer_load_dwordx4 v21, s[20:23], s41 offen lds
    s_add_u32 m0, s44, 83968
    s_add_u32 s41, s47, 16768
    buffer_load_dwordx4 v20, s[20:23], s41 offen lds
    s_add_u32 m0, s44, 84992
    s_add_u32 s41, s47, 16768
    buffer_load_dwordx4 v21, s[20:23], s41 offen lds
    s_waitcnt vmcnt(12)
    s_barrier
    s_add_u32 m0, s44, 32768
    s_add_u32 s41, s40, 786432
    buffer_load_dwordx4 v3, s[24:27], s41 offen lds
    s_add_u32 m0, s44, 33792
    s_add_u32 s41, s40, 811008
    buffer_load_dwordx4 v3, s[24:27], s41 offen lds
    s_add_u32 m0, s44, 34816
    s_add_u32 s41, s40, 835584
    buffer_load_dwordx4 v3, s[24:27], s41 offen lds
    s_add_u32 m0, s44, 35840
    s_add_u32 s41, s40, 860160
    buffer_load_dwordx4 v3, s[24:27], s41 offen lds
    s_add_u32 m0, s44, 131072
    s_add_u32 s41, s47, 512
    buffer_load_dwordx4 v20, s[20:23], s41 offen lds
    s_add_u32 m0, s44, 132096
    s_add_u32 s41, s47, 512
    buffer_load_dwordx4 v21, s[20:23], s41 offen lds
    s_add_u32 m0, s44, 133120
    s_add_u32 s41, s47, 16896
    buffer_load_dwordx4 v20, s[20:23], s41 offen lds
    s_add_u32 m0, s44, 134144
    s_add_u32 s41, s47, 16896
    buffer_load_dwordx4 v21, s[20:23], s41 offen lds
    s_add_u32 m0, s44, 147456
    s_add_u32 s41, s47, 640
    buffer_load_dwordx4 v20, s[20:23], s41 offen lds
    s_add_u32 m0, s44, 148480
    s_add_u32 s41, s47, 640
    buffer_load_dwordx4 v21, s[20:23], s41 offen lds
    s_add_u32 m0, s44, 149504
    s_add_u32 s41, s47, 17024
    buffer_load_dwordx4 v20, s[20:23], s41 offen lds
    s_add_u32 m0, s44, 150528
    s_add_u32 s41, s47, 17024
    buffer_load_dwordx4 v21, s[20:23], s41 offen lds
    v_mul_u32_u24 v4, 0xe00, v6
    v_lshl_add_u32 v4, v7, 4, v4
    v_xor_b32 v5, 32, v4
    s_lshr_b32 s43, s34, 2
    s_mul_i32 s43, s43, 896
    s_mul_i32 s45, s3, 114688
    s_add_u32 s43, s43, s45
    s_bfe_u32 s45, s34, 0x10001
    s_mov_b32 s8, s88
    s_and_b32 s9, s89, 0xffff
    s_mov_b32 s10, 0x1c0000
    s_mov_b32 s11, 0x00020000
    s_mov_b32 s36, s90
    s_and_b32 s37, s91, 0xffff
    s_mov_b32 s38, 0x1c0000
    s_mov_b32 s39, 0x00020000
    s_lshl_b32 s45, s45, 8
    s_add_u32 s43, s43, s45
    s_add_u32 s45, s43, 128
    s_waitcnt vmcnt(12)
    s_barrier
    s_add_u32 m0, s44, 49152
    s_add_u32 s41, s40, 1179648
    buffer_load_dwordx4 v3, s[24:27], s41 offen lds
    s_add_u32 m0, s44, 50176
    s_add_u32 s41, s40, 1204224
    buffer_load_dwordx4 v3, s[24:27], s41 offen lds
    s_add_u32 m0, s44, 51200
    s_add_u32 s41, s40, 1228800
    buffer_load_dwordx4 v3, s[24:27], s41 offen lds
    s_add_u32 m0, s44, 52224
    s_add_u32 s41, s40, 1253376
    buffer_load_dwordx4 v3, s[24:27], s41 offen lds
    s_add_u32 m0, s44, 0
    s_add_u32 s41, s47, 768
    buffer_load_dwordx4 v20, s[20:23], s41 offen lds
    s_add_u32 m0, s44, 1024
    s_add_u32 s41, s47, 768
    buffer_load_dwordx4 v21, s[20:23], s41 offen lds
    s_add_u32 m0, s44, 2048
    s_add_u32 s41, s47, 17152
    buffer_load_dwordx4 v20, s[20:23], s41 offen lds
    s_add_u32 m0, s44, 3072
    s_add_u32 s41, s47, 17152
    buffer_load_dwordx4 v21, s[20:23], s41 offen lds
    s_add_u32 m0, s44, 16384
    s_add_u32 s41, s47, 896
    buffer_load_dwordx4 v20, s[20:23], s41 offen lds
    s_add_u32 m0, s44, 17408
    s_add_u32 s41, s47, 896
    buffer_load_dwordx4 v21, s[20:23], s41 offen lds
    s_add_u32 m0, s44, 18432
    s_add_u32 s41, s47, 17280
    buffer_load_dwordx4 v20, s[20:23], s41 offen lds
    s_add_u32 m0, s44, 19456
    s_add_u32 s41, s47, 17280
    buffer_load_dwordx4 v21, s[20:23], s41 offen lds
    s_waitcnt vmcnt(12)
    s_barrier
    s_add_u32 m0, s44, 65536
    s_add_u32 s41, s43, 0
    buffer_load_dwordx4 v4, s[8:11], s41 offen lds
    s_add_u32 m0, s44, 66560
    s_add_u32 s41, s43, 28672
    buffer_load_dwordx4 v4, s[8:11], s41 offen lds
    s_add_u32 m0, s44, 67584
    s_add_u32 s41, s43, 57344
    buffer_load_dwordx4 v4, s[8:11], s41 offen lds
    s_add_u32 m0, s44, 68608
    s_add_u32 s41, s43, 86016
    buffer_load_dwordx4 v4, s[8:11], s41 offen lds
    s_add_u32 m0, s44, 81920
    s_add_u32 s41, s43, 0
    buffer_load_dwordx4 v5, s[36:39], s41 offen lds
    s_add_u32 m0, s44, 82944
    s_add_u32 s41, s43, 28672
    buffer_load_dwordx4 v5, s[36:39], s41 offen lds
    s_add_u32 m0, s44, 83968
    s_add_u32 s41, s43, 57344
    buffer_load_dwordx4 v5, s[36:39], s41 offen lds
    s_add_u32 m0, s44, 84992
    s_add_u32 s41, s43, 86016
    buffer_load_dwordx4 v5, s[36:39], s41 offen lds
    s_add_u32 m0, s44, 98304
    s_add_u32 s41, s43, 458752
    buffer_load_dwordx4 v4, s[8:11], s41 offen lds
    s_add_u32 m0, s44, 99328
    s_add_u32 s41, s43, 487424
    buffer_load_dwordx4 v4, s[8:11], s41 offen lds
    s_add_u32 m0, s44, 100352
    s_add_u32 s41, s43, 516096
    buffer_load_dwordx4 v4, s[8:11], s41 offen lds
    s_add_u32 m0, s44, 101376
    s_add_u32 s41, s43, 544768
    buffer_load_dwordx4 v4, s[8:11], s41 offen lds
    s_add_u32 m0, s44, 114688
    s_add_u32 s41, s43, 458752
    buffer_load_dwordx4 v5, s[36:39], s41 offen lds
    s_add_u32 m0, s44, 115712
    s_add_u32 s41, s43, 487424
    buffer_load_dwordx4 v5, s[36:39], s41 offen lds
    s_add_u32 m0, s44, 116736
    s_add_u32 s41, s43, 516096
    buffer_load_dwordx4 v5, s[36:39], s41 offen lds
    s_add_u32 m0, s44, 117760
    s_add_u32 s41, s43, 544768
    buffer_load_dwordx4 v5, s[36:39], s41 offen lds
    s_waitcnt vmcnt(16)
    s_barrier
    s_add_u32 m0, s44, 131072
    s_add_u32 s41, s43, 917504
    buffer_load_dwordx4 v4, s[8:11], s41 offen lds
    s_add_u32 m0, s44, 132096
    s_add_u32 s41, s43, 946176
    buffer_load_dwordx4 v4, s[8:11], s41 offen lds
    s_waitcnt vmcnt(10)
    s_barrier
    s_add_u32 m0, s44, 133120
    s_add_u32 s41, s43, 974848
    buffer_load_dwordx4 v4, s[8:11], s41 offen lds
    s_add_u32 m0, s44, 134144
    s_add_u32 s41, s43, 1003520
    buffer_load_dwordx4 v4, s[8:11], s41 offen lds
    s_add_u32 m0, s44, 147456
    s_add_u32 s41, s43, 917504
    buffer_load_dwordx4 v5, s[36:39], s41 offen lds
    s_add_u32 m0, s44, 148480
    s_add_u32 s41, s43, 946176
    buffer_load_dwordx4 v5, s[36:39], s41 offen lds
    s_add_u32 m0, s44, 149504
    s_add_u32 s41, s43, 974848
    buffer_load_dwordx4 v5, s[36:39], s41 offen lds
    s_add_u32 m0, s44, 150528
    s_add_u32 s41, s43, 1003520
    buffer_load_dwordx4 v5, s[36:39], s41 offen lds
    s_add_u32 m0, s44, 0
    s_add_u32 s41, s43, 1376256
    buffer_load_dwordx4 v4, s[8:11], s41 offen lds
    s_add_u32 m0, s44, 1024
    s_add_u32 s41, s43, 1404928
    buffer_load_dwordx4 v4, s[8:11], s41 offen lds
    s_waitcnt vmcnt(10)
    s_barrier
    s_add_u32 m0, s44, 2048
    s_add_u32 s41, s43, 1433600
    buffer_load_dwordx4 v4, s[8:11], s41 offen lds
    s_add_u32 m0, s44, 3072
    s_add_u32 s41, s43, 1462272
    buffer_load_dwordx4 v4, s[8:11], s41 offen lds
    s_add_u32 m0, s44, 16384
    s_add_u32 s41, s43, 1376256
    buffer_load_dwordx4 v5, s[36:39], s41 offen lds
    s_add_u32 m0, s44, 17408
    s_add_u32 s41, s43, 1404928
    buffer_load_dwordx4 v5, s[36:39], s41 offen lds
    s_add_u32 m0, s44, 18432
    s_add_u32 s41, s43, 1433600
    buffer_load_dwordx4 v5, s[36:39], s41 offen lds
    s_add_u32 m0, s44, 19456
    s_add_u32 s41, s43, 1462272
    buffer_load_dwordx4 v5, s[36:39], s41 offen lds
    s_add_u32 m0, s44, 32768
    s_add_u32 s41, s45, 0
    buffer_load_dwordx4 v4, s[8:11], s41 offen lds
    s_add_u32 m0, s44, 33792
    s_add_u32 s41, s45, 28672
    buffer_load_dwordx4 v4, s[8:11], s41 offen lds
    s_waitcnt vmcnt(10)
    s_barrier
    s_add_u32 m0, s44, 34816
    s_add_u32 s41, s45, 57344
    buffer_load_dwordx4 v4, s[8:11], s41 offen lds
    s_add_u32 m0, s44, 35840
    s_add_u32 s41, s45, 86016
    buffer_load_dwordx4 v4, s[8:11], s41 offen lds
    s_add_u32 m0, s44, 49152
    s_add_u32 s41, s45, 0
    buffer_load_dwordx4 v5, s[36:39], s41 offen lds
    s_add_u32 m0, s44, 50176
    s_add_u32 s41, s45, 28672
    buffer_load_dwordx4 v5, s[36:39], s41 offen lds
    s_add_u32 m0, s44, 51200
    s_add_u32 s41, s45, 57344
    buffer_load_dwordx4 v5, s[36:39], s41 offen lds
    s_add_u32 m0, s44, 52224
    s_add_u32 s41, s45, 86016
    buffer_load_dwordx4 v5, s[36:39], s41 offen lds
    s_waitcnt vmcnt(8)
    s_barrier
    s_barrier
    s_barrier
    s_branch KF_G1
KF_G0:
    s_add_u32 m0, s44, 32768
    s_add_u32 s41, s40, 0
    buffer_load_dwordx4 v3, s[24:27], s41 offen lds
    s_add_u32 m0, s44, 33792
    s_add_u32 s41, s40, 24576
    buffer_load_dwordx4 v3, s[24:27], s41 offen lds
    s_add_u32 m0, s44, 34816
    s_add_u32 s41, s40, 49152
    buffer_load_dwordx4 v3, s[24:27], s41 offen lds
    s_add_u32 m0, s44, 35840
    s_add_u32 s41, s40, 73728
    buffer_load_dwordx4 v3, s[24:27], s41 offen lds
    s_add_u32 m0, s44, 98304
    s_add_u32 s41, s47, 0
    buffer_load_dwordx4 v20, s[20:23], s41 offen lds
    s_add_u32 m0, s44, 99328
    s_add_u32 s41, s47, 0
    buffer_load_dwordx4 v21, s[20:23], s41 offen lds
    s_add_u32 m0, s44, 100352
    s_add_u32 s41, s47, 16384
    buffer_load_dwordx4 v20, s[20:23], s41 offen lds
    s_add_u32 m0, s44, 101376
    s_add_u32 s41, s47, 16384
    buffer_load_dwordx4 v21, s[20:23], s41 offen lds
    s_add_u32 m0, s44, 114688
    s_add_u32 s41, s47, 128
    buffer_load_dwordx4 v20, s[20:23], s41 offen lds
    s_add_u32 m0, s44, 115712
    s_add_u32 s41, s47, 128
    buffer_load_dwordx4 v21, s[20:23], s41 offen lds
    s_add_u32 m0, s44, 116736
    s_add_u32 s41, s47, 16512
    buffer_load_dwordx4 v20, s[20:23], s41 offen lds
    s_add_u32 m0, s44, 117760
    s_add_u32 s41, s47, 16512
    buffer_load_dwordx4 v21, s[20:23], s41 offen lds
    s_add_u32 m0, s44, 49152
    s_add_u32 s41, s40, 393216
    buffer_load_dwordx4 v3, s[24:27], s41 offen lds
    s_add_u32 m0, s44, 50176
    s_add_u32 s41, s40, 417792
    buffer_load_dwordx4 v3, s[24:27], s41 offen lds
    s_add_u32 m0, s44, 51200
    s_add_u32 s41, s40, 442368
    buffer_load_dwordx4 v3, s[24:27], s41 offen lds
    s_add_u32 m0, s44, 52224
    s_add_u32 s41, s40, 466944
    buffer_load_dwordx4 v3, s[24:27], s41 offen lds
    s_add_u32 m0, s44, 0
    s_add_u32 s41, s47, 256
    buffer_load_dwordx4 v20, s[20:23], s41 offen lds
    s_add_u32 m0, s44, 1024
    s_add_u32 s41, s47, 256
    buffer_load_dwordx4 v21, s[20:23], s41 offen lds
    s_add_u32 m0, s44, 2048
    s_add_u32 s41, s47, 16640
    buffer_load_dwordx4 v20, s[20:23], s41 offen lds
    s_add_u32 m0, s44, 3072
    s_add_u32 s41, s47, 16640
    buffer_load_dwordx4 v21, s[20:23], s41 offen lds
    s_add_u32 m0, s44, 16384
    s_add_u32 s41, s47, 384
    buffer_load_dwordx4 v20, s[20:23], s41 offen lds
    s_add_u32 m0, s44, 17408
    s_add_u32 s41, s47, 384
    buffer_load_dwordx4 v21, s[20:23], s41 offen lds
    s_add_u32 m0, s44, 18432
    s_add_u32 s41, s47, 16768
    buffer_load_dwordx4 v20, s[20:23], s41 offen lds
    s_add_u32 m0, s44, 19456
    s_add_u32 s41, s47, 16768
    buffer_load_dwordx4 v21, s[20:23], s41 offen lds
    s_waitcnt vmcnt(12)
    s_barrier
    s_add_u32 m0, s44, 131072
    s_add_u32 s41, s40, 786432
    buffer_load_dwordx4 v3, s[24:27], s41 offen lds
    s_add_u32 m0, s44, 132096
    s_add_u32 s41, s40, 811008
    buffer_load_dwordx4 v3, s[24:27], s41 offen lds
    s_add_u32 m0, s44, 133120
    s_add_u32 s41, s40, 835584
    buffer_load_dwordx4 v3, s[24:27], s41 offen lds
    s_add_u32 m0, s44, 134144
    s_add_u32 s41, s40, 860160
    buffer_load_dwordx4 v3, s[24:27], s41 offen lds
    s_add_u32 m0, s44, 65536
    s_add_u32 s41, s47, 512
    buffer_load_dwordx4 v20, s[20:23], s41 offen lds
    s_add_u32 m0, s44, 66560
    s_add_u32 s41, s47, 512
    buffer_load_dwordx4 v21, s[20:23], s41 offen lds
    s_add_u32 m0, s44, 67584
    s_add_u32 s41, s47, 16896
    buffer_load_dwordx4 v20, s[20:23], s41 offen lds
    s_add_u32 m0, s44, 68608
    s_add_u32 s41, s47, 16896
    buffer_load_dwordx4 v21, s[20:23], s41 offen lds
    s_add_u32 m0, s44, 81920
    s_add_u32 s41, s47, 640
    buffer_load_dwordx4 v20, s[20:23], s41 offen lds
    s_add_u32 m0, s44, 82944
    s_add_u32 s41, s47, 640
    buffer_load_dwordx4 v21, s[20:23], s41 offen lds
    s_add_u32 m0, s44, 83968
    s_add_u32 s41, s47, 17024
    buffer_load_dwordx4 v20, s[20:23], s41 offen lds
    s_add_u32 m0, s44, 84992
    s_add_u32 s41, s47, 17024
    buffer_load_dwordx4 v21, s[20:23], s41 offen lds
    v_mul_u32_u24 v4, 0xe00, v6
    v_lshl_add_u32 v4, v7, 4, v4
    v_xor_b32 v5, 32, v4
    s_lshr_b32 s43, s34, 2
    s_mul_i32 s43, s43, 896
    s_mul_i32 s45, s3, 114688
    s_add_u32 s43, s43, s45
    s_bfe_u32 s45, s34, 0x10001
    s_mov_b32 s8, s88
    s_and_b32 s9, s89, 0xffff
    s_mov_b32 s10, 0x1c0000
    s_mov_b32 s11, 0x00020000
    s_mov_b32 s36, s90
    s_and_b32 s37, s91, 0xffff
    s_mov_b32 s38, 0x1c0000
    s_mov_b32 s39, 0x00020000
    s_lshl_b32 s45, s45, 7
    s_add_u32 s45, s45, s43
    s_add_u32 s45, s45, 512
    s_add_u32 s43, s43, 768
    s_waitcnt vmcnt(12)
    s_barrier
    s_add_u32 m0, s44, 147456
    s_add_u32 s41, s40, 1179648
    buffer_load_dwordx4 v3, s[24:27], s41 offen lds
    s_add_u32 m0, s44, 148480
    s_add_u32 s41, s40, 1204224
    buffer_load_dwordx4 v3, s[24:27], s41 offen lds
    s_add_u32 m0, s44, 149504
    s_add_u32 s41, s40, 1228800
    buffer_load_dwordx4 v3, s[24:27], s41 offen lds
    s_add_u32 m0, s44, 150528
    s_add_u32 s41, s40, 1253376
    buffer_load_dwordx4 v3, s[24:27], s41 offen lds
    s_add_u32 m0, s44, 98304
    s_add_u32 s41, s47, 768
    buffer_load_dwordx4 v20, s[20:23], s41 offen lds
    s_add_u32 m0, s44, 99328
    s_add_u32 s41, s47, 768
    buffer_load_dwordx4 v21, s[20:23], s41 offen lds
    s_add_u32 m0, s44, 100352
    s_add_u32 s41, s47, 17152
    buffer_load_dwordx4 v20, s[20:23], s41 offen lds
    s_add_u32 m0, s44, 101376
    s_add_u32 s41, s47, 17152
    buffer_load_dwordx4 v21, s[20:23], s41 offen lds
    s_add_u32 m0, s44, 114688
    s_add_u32 s41, s47, 896
    buffer_load_dwordx4 v20, s[20:23], s41 offen lds
    s_add_u32 m0, s44, 115712
    s_add_u32 s41, s47, 896
    buffer_load_dwordx4 v21, s[20:23], s41 offen lds
    s_add_u32 m0, s44, 116736
    s_add_u32 s41, s47, 17280
    buffer_load_dwordx4 v20, s[20:23], s41 offen lds
    s_add_u32 m0, s44, 117760
    s_add_u32 s41, s47, 17280
    buffer_load_dwordx4 v21, s[20:23], s41 offen lds
    s_waitcnt vmcnt(12)
    s_barrier
    s_add_u32 m0, s44, 0
    s_add_u32 s41, s42, 0
    buffer_load_dwordx4 v3, s[24:27], s41 offen lds
    s_add_u32 m0, s44, 1024
    s_add_u32 s41, s42, 24576
    buffer_load_dwordx4 v3, s[24:27], s41 offen lds
    s_add_u32 m0, s44, 2048
    s_add_u32 s41, s42, 49152
    buffer_load_dwordx4 v3, s[24:27], s41 offen lds
    s_add_u32 m0, s44, 3072
    s_add_u32 s41, s42, 73728
    buffer_load_dwordx4 v3, s[24:27], s41 offen lds
    s_add_u32 m0, s44, 16384
    s_add_u32 s41, s42, 393216
    buffer_load_dwordx4 v3, s[24:27], s41 offen lds
    s_add_u32 m0, s44, 17408
    s_add_u32 s41, s42, 417792
    buffer_load_dwordx4 v3, s[24:27], s41 offen lds
    s_add_u32 m0, s44, 18432
    s_add_u32 s41, s42, 442368
    buffer_load_dwordx4 v3, s[24:27], s41 offen lds
    s_add_u32 m0, s44, 19456
    s_add_u32 s41, s42, 466944
    buffer_load_dwordx4 v3, s[24:27], s41 offen lds
    s_add_u32 m0, s44, 32768
    s_add_u32 s41, s42, 786432
    buffer_load_dwordx4 v3, s[24:27], s41 offen lds
    s_add_u32 m0, s44, 33792
    s_add_u32 s41, s42, 811008
    buffer_load_dwordx4 v3, s[24:27], s41 offen lds
    s_add_u32 m0, s44, 34816
    s_add_u32 s41, s42, 835584
    buffer_load_dwordx4 v3, s[24:27], s41 offen lds
    s_add_u32 m0, s44, 35840
    s_add_u32 s41, s42, 860160
    buffer_load_dwordx4 v3, s[24:27], s41 offen lds
    s_add_u32 m0, s44, 49152
    s_add_u32 s41, s42, 1179648
    buffer_load_dwordx4 v3, s[24:27], s41 offen lds
    s_add_u32 m0, s44, 50176
    s_add_u32 s41, s42, 1204224
    buffer_load_dwordx4 v3, s[24:27], s41 offen lds
    s_add_u32 m0, s44, 51200
    s_add_u32 s41, s42, 1228800
    buffer_load_dwordx4 v3, s[24:27], s41 offen lds
    s_add_u32 m0, s44, 52224
    s_add_u32 s41, s42, 1253376
    buffer_load_dwordx4 v3, s[24:27], s41 offen lds
    s_waitcnt vmcnt(16)
    s_barrier
    s_add_u32 m0, s44, 65536
    s_add_u32 s41, s43, 0
    buffer_load_dwordx4 v4, s[8:11], s41 offen lds
    s_add_u32 m0, s44, 66560
    s_add_u32 s41, s43, 28672
    buffer_load_dwordx4 v4, s[8:11], s41 offen lds
    s_waitcnt vmcnt(14)
    s_barrier
    s_add_u32 m0, s44, 67584
    s_add_u32 s41, s43, 57344
    buffer_load_dwordx4 v4, s[8:11], s41 offen lds
    s_add_u32 m0, s44, 68608
    s_add_u32 s41, s43, 86016
    buffer_load_dwordx4 v4, s[8:11], s41 offen lds
    s_add_u32 m0, s44, 81920
    s_add_u32 s41, s43, 0
    buffer_load_dwordx4 v5, s[36:39], s41 offen lds
    s_add_u32 m0, s44, 82944
    s_add_u32 s41, s43, 28672
    buffer_load_dwordx4 v5, s[36:39], s41 offen lds
    s_add_u32 m0, s44, 83968
    s_add_u32 s41, s43, 57344
    buffer_load_dwordx4 v5, s[36:39], s41 offen lds
    s_add_u32 m0, s44, 84992
    s_add_u32 s41, s43, 86016
    buffer_load_dwordx4 v5, s[36:39], s41 offen lds
    s_add_u32 m0, s44, 98304
    s_add_u32 s41, s43, 458752
    buffer_load_dwordx4 v4, s[8:11], s41 offen lds
    s_waitcnt vmcnt(17)
    s_barrier
    s_add_u32 m0, s44, 99328
    s_add_u32 s41, s43, 487424
    buffer_load_dwordx4 v4, s[8:11], s41 offen lds
    s_add_u32 m0, s44, 100352
    s_add_u32 s41, s43, 516096
    buffer_load_dwordx4 v4, s[8:11], s41 offen lds
    s_add_u32 m0, s44, 101376
    s_add_u32 s41, s43, 544768
    buffer_load_dwordx4 v4, s[8:11], s41 offen lds
    s_add_u32 m0, s44, 114688
    s_add_u32 s41, s43, 458752
    buffer_load_dwordx4 v5, s[36:39], s41 offen lds
    s_add_u32 m0, s44, 115712
    s_add_u32 s41, s43, 487424
    buffer_load_dwordx4 v5, s[36:39], s41 offen lds
    s_add_u32 m0, s44, 116736
    s_add_u32 s41, s43, 516096
    buffer_load_dwordx4 v5, s[36:39], s41 offen lds
    s_add_u32 m0, s44, 117760
    s_add_u32 s41, s43, 544768
    buffer_load_dwordx4 v5, s[36:39], s41 offen lds
    s_waitcnt vmcnt(20)
    s_barrier
    s_add_u32 m0, s44, 131072
    s_add_u32 s41, s43, 917504
    buffer_load_dwordx4 v4, s[8:11], s41 offen lds
    s_add_u32 m0, s44, 132096
    s_add_u32 s41, s43, 946176
    buffer_load_dwordx4 v4, s[8:11], s41 offen lds
    s_add_u32 m0, s44, 133120
    s_add_u32 s41, s43, 974848
    buffer_load_dwordx4 v4, s[8:11], s41 offen lds
    s_add_u32 m0, s44, 134144
    s_add_u32 s41, s43, 1003520
    buffer_load_dwordx4 v4, s[8:11], s41 offen lds
    s_add_u32 m0, s44, 147456
    s_add_u32 s41, s43, 917504
    buffer_load_dwordx4 v5, s[36:39], s41 offen lds
    s_add_u32 m0, s44, 148480
    s_add_u32 s41, s43, 946176
    buffer_load_dwordx4 v5, s[36:39], s41 offen lds
    s_add_u32 m0, s44, 149504
    s_add_u32 s41, s43, 974848
    buffer_load_dwordx4 v5, s[36:39], s41 offen lds
    s_waitcnt vmcnt(23)
    s_barrier
    s_add_u32 m0, s44, 150528
    s_add_u32 s41, s43, 1003520
    buffer_load_dwordx4 v5, s[36:39], s41 offen lds
    s_add_u32 m0, s44, 0
    s_add_u32 s41, s43, 1376256
    buffer_load_dwordx4 v4, s[8:11], s41 offen lds
    s_add_u32 m0, s44, 1024
    s_add_u32 s41, s43, 1404928
    buffer_load_dwordx4 v4, s[8:11], s41 offen lds
    s_add_u32 m0, s44, 2048
    s_add_u32 s41, s43, 1433600
    buffer_load_dwordx4 v4, s[8:11], s41 offen lds
    s_add_u32 m0, s44, 3072
    s_add_u32 s41, s43, 1462272
    buffer_load_dwordx4 v4, s[8:11], s41 offen lds
    s_add_u32 m0, s44, 16384
    s_add_u32 s41, s43, 1376256
    buffer_load_dwordx4 v5, s[36:39], s41 offen lds
    s_add_u32 m0, s44, 17408
    s_add_u32 s41, s43, 1404928
    buffer_load_dwordx4 v5, s[36:39], s41 offen lds
    s_waitcnt vmcnt(22)
    s_barrier
    s_add_u32 m0, s44, 18432
    s_add_u32 s41, s43, 1433600
    buffer_load_dwordx4 v5, s[36:39], s41 offen lds
    s_add_u32 m0, s44, 19456
    s_add_u32 s41, s43, 1462272
    buffer_load_dwordx4 v5, s[36:39], s41 offen lds
    s_waitcnt vmcnt(16)
    s_barrier
    s_add_u32 m0, s44, 32768
    s_add_u32 s41, s45, 0
    buffer_load_dwordx4 v4, s[8:11], s41 offen lds
    s_add_u32 m0, s44, 33792
    s_add_u32 s41, s45, 28672
    buffer_load_dwordx4 v4, s[8:11], s41 offen lds
    s_add_u32 m0, s44, 34816
    s_add_u32 s41, s45, 57344
    buffer_load_dwordx4 v4, s[8:11], s41 offen lds
    s_add_u32 m0, s44, 35840
    s_add_u32 s41, s45, 86016
    buffer_load_dwordx4 v4, s[8:11], s41 offen lds
    s_add_u32 m0, s44, 49152
    s_add_u32 s41, s45, 0
    buffer_load_dwordx4 v5, s[36:39], s41 offen lds
    s_add_u32 m0, s44, 50176
    s_add_u32 s41, s45, 28672
    buffer_load_dwordx4 v5, s[36:39], s41 offen lds
    s_add_u32 m0, s44, 51200
    s_add_u32 s41, s45, 57344
    buffer_load_dwordx4 v5, s[36:39], s41 offen lds
    s_add_u32 m0, s44, 52224
    s_add_u32 s41, s45, 86016
    buffer_load_dwordx4 v5, s[36:39], s41 offen lds
KF_G1:
    s_mov_b32 s16, s14
    s_and_b32 s17, s15, 0xffff
    s_mov_b32 s18, 0x1600000
    s_mov_b32 s19, 0x00020000
    s_lshl_b32 s48, s34, 10
    s_lshl_b32 s53, s3, 8
    s_add_u32 s48, s48, s53
    s_add_u32 s48, s48, 0x1410000
    s_lshl_b32 s53, s34, 4
    s_add_u32 s53, s53, s35
    s_lshl_b32 s53, s53, 5
    s_add_u32 s53, s53, 0x141c000
    v_lshrrev_b32 v19, 1, v1
    v_and_b32 v17, 24, v19
    v_add_u32 v19, s48, v19
    v_add_u32 v17, s53, v17
    v_cmp_gt_u32 vcc, 0x200, v1
    s_nop 1
    v_cndmask_b32 v19, v17, v19, vcc
    v_and_b32 v20, 7, v2
    v_lshlrev_b32 v20, 7, v20
    v_bfe_u32 v21, v2, 3, 1
    v_lshl_add_u32 v20, v21, 16, v20
    v_bfe_u32 v21, v2, 4, 1
    v_lshl_add_u32 v20, v21, 21, v20
    v_lshrrev_b32 v21, 5, v2
    v_lshlrev_b32 v21, 15, v21
    s_lshl_b32 s48, s35, 12
    v_xor_b32 v21, s48, v21
    s_lshl_b32 s48, s34, 17
    s_lshl_b32 s53, s3, 10
    s_add_u32 s48, s48, s53
    v_add3_u32 v20, v20, v21, s48
    s_waitcnt vmcnt(16)
    s_barrier
    s_add_u32 m0, s44, 65536
    s_add_u32 s41, s45, 458752
    buffer_load_dwordx4 v4, s[8:11], s41 offen lds
    s_add_u32 m0, s44, 66560
    s_add_u32 s41, s45, 487424
    buffer_load_dwordx4 v4, s[8:11], s41 offen lds
    s_add_u32 m0, s44, 67584
    s_add_u32 s41, s45, 516096
    buffer_load_dwordx4 v4, s[8:11], s41 offen lds
    s_add_u32 m0, s44, 68608
    s_add_u32 s41, s45, 544768
    buffer_load_dwordx4 v4, s[8:11], s41 offen lds
    s_add_u32 m0, s44, 81920
    s_add_u32 s41, s45, 458752
    buffer_load_dwordx4 v5, s[36:39], s41 offen lds
    s_add_u32 m0, s44, 82944
    s_add_u32 s41, s45, 487424
    buffer_load_dwordx4 v5, s[36:39], s41 offen lds
    s_and_b32 s34, s33, 3
    s_lshr_b32 s35, s33, 2
    s_lshl_b32 s58, s32, 2
    s_add_u32 s58, s58, s34
    s_lshl_b32 s59, s58, 3
    s_add_u32 s59, s59, s35
    s_lshl_b32 s59, s59, 2
    s_add_u32 s59, s59, s3
    s_sub_u32 s56, s56, 1600
    s_subb_u32 s57, s57, 0
    v_and_b32 v14, 3, v2
    v_mul_u32_u24 v14, 0x104, v14
    v_add_u32 v14, 2048, v14
    v_lshlrev_b32 v15, 2, v0
    v_add_u32 v15, 0, v15
    v_mov_b32 v11, s57
    s_load_dwordx2 s[12:13], s[0:1], 16
    s_waitcnt vmcnt(14)
    s_barrier
    s_add_u32 m0, s44, 83968
    s_add_u32 s41, s45, 516096
    buffer_load_dwordx4 v5, s[36:39], s41 offen lds
    s_add_u32 m0, s44, 84992
    s_add_u32 s41, s45, 544768
    buffer_load_dwordx4 v5, s[36:39], s41 offen lds
    s_add_u32 m0, s44, 98304
    s_add_u32 s41, s45, 917504
    buffer_load_dwordx4 v4, s[8:11], s41 offen lds
    s_add_u32 m0, s44, 99328
    s_add_u32 s41, s45, 946176
    buffer_load_dwordx4 v4, s[8:11], s41 offen lds
    s_add_u32 m0, s44, 100352
    s_add_u32 s41, s45, 974848
    buffer_load_dwordx4 v4, s[8:11], s41 offen lds
    s_add_u32 m0, s44, 101376
    s_add_u32 s41, s45, 1003520
    buffer_load_dwordx4 v4, s[8:11], s41 offen lds
    s_waitcnt vmcnt(12)
    s_barrier
    s_add_u32 m0, s44, 114688
    s_add_u32 s41, s45, 917504
    buffer_load_dwordx4 v5, s[36:39], s41 offen lds
    s_add_u32 m0, s44, 115712
    s_add_u32 s41, s45, 946176
    buffer_load_dwordx4 v5, s[36:39], s41 offen lds
    s_add_u32 m0, s44, 116736
    s_add_u32 s41, s45, 974848
    buffer_load_dwordx4 v5, s[36:39], s41 offen lds
    s_add_u32 m0, s44, 117760
    s_add_u32 s41, s45, 1003520
    buffer_load_dwordx4 v5, s[36:39], s41 offen lds
    s_add_u32 m0, s44, 131072
    s_add_u32 s41, s45, 1376256
    buffer_load_dwordx4 v4, s[8:11], s41 offen lds
    s_add_u32 m0, s44, 132096
    s_add_u32 s41, s45, 1404928
    buffer_load_dwordx4 v4, s[8:11], s41 offen lds
    s_waitcnt vmcnt(10)
    s_barrier
    s_add_u32 m0, s44, 133120
    s_add_u32 s41, s45, 1433600
    buffer_load_dwordx4 v4, s[8:11], s41 offen lds
    s_add_u32 m0, s44, 134144
    s_add_u32 s41, s45, 1462272
    buffer_load_dwordx4 v4, s[8:11], s41 offen lds
    s_add_u32 m0, s44, 147456
    s_add_u32 s41, s45, 1376256
    buffer_load_dwordx4 v5, s[36:39], s41 offen lds
    s_add_u32 m0, s44, 148480
    s_add_u32 s41, s45, 1404928
    buffer_load_dwordx4 v5, s[36:39], s41 offen lds
    s_add_u32 m0, s44, 149504
    s_add_u32 s41, s45, 1433600
    buffer_load_dwordx4 v5, s[36:39], s41 offen lds
    s_add_u32 m0, s44, 150528
    s_add_u32 s41, s45, 1462272
    buffer_load_dwordx4 v5, s[36:39], s41 offen lds
    v_mov_b32 v18, 0
    v_mov_b32 v17, 1
    ds_write_b32 v15, v18
    ds_write_b32 v15, v17 offset:1024
    s_waitcnt lgkmcnt(0)
    s_waitcnt vmcnt(8)
    s_barrier
    buffer_load_dwordx2 v[12:13], v19, s[16:19], 0 offen sc1
    s_mov_b32 s24, s94
    s_and_b32 s25, s95, 0xffff
    s_mov_b32 s26, 0x400
    s_mov_b32 s27, 0x00020000
    s_mov_b32 s28, s92
    s_and_b32 s29, s93, 0xffff
    s_mov_b32 s30, 0x1c0000
    s_mov_b32 s31, 0x00020000
    s_waitcnt vmcnt(1)
    s_barrier
    s_mov_b32 s40, 2
KF_P0:
    s_waitcnt vmcnt(0)
    v_subrev_co_u32 v12, vcc, s56, v12
    s_nop 1
    v_subb_co_u32 v13, vcc, v13, v11, vcc
    v_lshrrev_b32 v12, 24, v12
    v_or_b32 v12, v12, v13
    v_cmp_ne_u32 vcc, 0, v12
    s_and_b64 vcc, vcc, s[98:99]
    s_cbranch_vccz KF_P1
    s_cmp_eq_u32 s40, 0
    s_cbranch_scc1 KF_P2
    s_sub_u32 s40, s40, 1
    buffer_load_dwordx2 v[12:13], v19, s[16:19], 0 offen sc1
    s_branch KF_P0
KF_P1:
    ds_write_b32 v15, v18 offset:1024
KF_P2:
    s_setprio 1
    v_mov_b32 v37, 0
    s_lshl_b32 s41, s58, 9
    s_lshl_b32 s42, s3, 7
    s_add_u32 s41, s41, s42
    s_add_u32 s41, s41, 0x1418000
    s_lshl_b32 s42, s35, 7
    s_mul_i32 s43, s3, 16384
    s_add_u32 s43, s43, 65536
    s_mul_i32 s44, s3, 458752
    s_add_u32 s45, s44, 8192
    s_mul_i32 s46, s58, 229376
    s_mul_i32 s47, s3, 28672
    s_add_u32 s46, s46, s47
    s_add_u32 s46, s46, 0x800000
    s_add_u32 s47, s46, 114688
    v_bfe_u32 v17, v2, 2, 2
    v_lshrrev_b32 v18, 5, v2
    v_lshl_add_u32 v8, v18, 2, v17
    v_lshlrev_b32 v8, 7, v8
    v_lshrrev_b32 v17, 1, v17
    v_lshl_add_u32 v8, v17, 6, v8
    v_bfe_u32 v17, v2, 4, 1
    v_lshl_add_u32 v8, v17, 5, v8
    v_and_b32 v17, 3, v2
    v_lshl_add_u32 v8, v17, 3, v8
    v_add_u32 v8, s43, v8
    v_xor_b32 v9, 64, v8
    v_lshrrev_b32 v17, 3, v2
    v_bfe_u32 v18, v2, 4, 1
    v_lshlrev_b32 v18, 2, v18
    v_and_b32 v10, 7, v2
    v_xor_b32 v10, v10, v18
    v_lshlrev_b32 v10, 4, v10
    v_lshl_add_u32 v10, v17, 10, v10
    v_add_u32 v10, s42, v10
    v_mov_b32 v92, 0
    v_mov_b32 v93, 0
    v_mov_b32 v94, 0
    v_mov_b32 v95, 0
    v_mov_b32 v96, 0
    v_mov_b32 v97, 0
    v_mov_b32 v98, 0
    v_mov_b32 v99, 0
    v_mov_b32 v100, 0
    v_mov_b32 v101, 0
    v_mov_b32 v102, 0
    v_mov_b32 v103, 0
    v_mov_b32 v104, 0
    v_mov_b32 v105, 0
    v_mov_b32 v106, 0
    v_mov_b32 v107, 0
    v_mov_b32 v108, 0
    v_mov_b32 v109, 0
    v_mov_b32 v110, 0
    v_mov_b32 v111, 0
    v_mov_b32 v112, 0
    v_mov_b32 v113, 0
    v_mov_b32 v114, 0
    v_mov_b32 v115, 0
    v_mov_b32 v116, 0
    v_mov_b32 v117, 0
    v_mov_b32 v118, 0
    v_mov_b32 v119, 0
    v_mov_b32 v120, 0
    v_mov_b32 v121, 0
    v_mov_b32 v122, 0
    v_mov_b32 v123, 0
    v_mov_b32 v124, 0
    v_mov_b32 v125, 0
    v_mov_b32 v126, 0
    v_mov_b32 v127, 0
    v_mov_b32 v128, 0
    v_mov_b32 v129, 0
    v_mov_b32 v130, 0
    v_mov_b32 v131, 0
    v_mov_b32 v132, 0
    v_mov_b32 v133, 0
    v_mov_b32 v134, 0
    v_mov_b32 v135, 0
    v_mov_b32 v136, 0
    v_mov_b32 v137, 0
    v_mov_b32 v138, 0
    v_mov_b32 v139, 0
    v_mov_b32 v140, 0
    v_mov_b32 v141, 0
    v_mov_b32 v142, 0
    v_mov_b32 v143, 0
    v_mov_b32 v144, 0
    v_mov_b32 v145, 0
    v_mov_b32 v146, 0
    v_mov_b32 v147, 0
    v_mov_b32 v148, 0
    v_mov_b32 v149, 0
    v_mov_b32 v150, 0
    v_mov_b32 v151, 0
    v_mov_b32 v152, 0
    v_mov_b32 v153, 0
    v_mov_b32 v154, 0
    v_mov_b32 v155, 0
    s_barrier
    s_setprio 3
    s_sleep 10
    v_subrev_u32 v17, 0x200, v0
    v_lshlrev_b32 v17, 5, v17
    v_and_b32 v18, 31, v0
    v_lshlrev_b32 v18, 5, v18
    s_lshl_b32 s40, s2, 13
    buffer_load_dwordx4 v[20:23], v17, s[20:23], s40 offen
    buffer_load_dwordx4 v[24:27], v17, s[20:23], s40 offen offset:16
    buffer_load_dwordx4 v[28:31], v18, s[24:27], 0 offen
    buffer_load_dwordx4 v[32:35], v18, s[24:27], 0 offen offset:16
    s_add_u32 m0, s43, 0
    s_nop 0
    buffer_load_dwordx4 v10, s[28:31], s44 offen lds
    s_add_u32 m0, s43, 1024
    s_add_u32 s44, s44, 0x4000
    buffer_load_dwordx4 v10, s[28:31], s45 offen lds
    s_add_u32 s45, s45, 0x4000
    s_sleep 6
    s_add_u32 m0, s43, 2048
    s_nop 0
    buffer_load_dwordx4 v10, s[28:31], s44 offen lds
    s_add_u32 m0, s43, 3072
    s_add_u32 s44, s44, 0x4000
    buffer_load_dwordx4 v10, s[28:31], s45 offen lds
    s_add_u32 s45, s45, 0x4000
    s_sleep 6
    s_add_u32 m0, s43, 4096
    s_nop 0
    buffer_load_dwordx4 v10, s[28:31], s44 offen lds
    s_add_u32 m0, s43, 5120
    s_add_u32 s44, s44, 0x4000
    buffer_load_dwordx4 v10, s[28:31], s45 offen lds
    s_add_u32 s45, s45, 0x4000
    s_sleep 6
    s_add_u32 m0, s43, 6144
    s_nop 0
    buffer_load_dwordx4 v10, s[28:31], s44 offen lds
    s_add_u32 m0, s43, 7168
    s_add_u32 s44, s44, 0x4000
    buffer_load_dwordx4 v10, s[28:31], s45 offen lds
    s_add_u32 s45, s45, 0x4000
    s_sleep 6
    s_add_u32 m0, s43, 8192
    s_nop 0
    buffer_load_dwordx4 v10, s[28:31], s44 offen lds
    s_add_u32 m0, s43, 9216
    s_add_u32 s44, s44, 0x4000
    buffer_load_dwordx4 v10, s[28:31], s45 offen lds
    s_add_u32 s45, s45, 0x4000
    s_sleep 6
    s_add_u32 m0, s43, 10240
    s_nop 0
    buffer_load_dwordx4 v10, s[28:31], s44 offen lds
    s_add_u32 m0, s43, 11264
    s_add_u32 s44, s44, 0x4000
    buffer_load_dwordx4 v10, s[28:31], s45 offen lds
    s_add_u32 s45, s45, 0x4000
    s_sleep 6
    s_add_u32 m0, s43, 12288
    s_nop 0
    buffer_load_dwordx4 v10, s[28:31], s44 offen lds
    s_add_u32 m0, s43, 13312
    s_add_u32 s44, s44, 0x4000
    buffer_load_dwordx4 v10, s[28:31], s45 offen lds
    s_add_u32 s45, s45, 0x4000
    s_sleep 6
    s_waitcnt vmcnt(14)
    v_lshlrev_b32 v38, 16, v20
    v_and_b32 v39, 0xffff0000, v20
    v_lshlrev_b32 v40, 16, v28
    v_and_b32 v41, 0xffff0000, v28
    v_mul_f32 v38, v38, v40
    v_mul_f32 v39, v39, v41
    v_cvt_pk_bf16_f32 v38, v38, v39
    v_lshlrev_b32 v39, 16, v38
    v_and_b32 v38, 0xffff0000, v38
    v_add_f32 v37, v37, v39
    v_add_f32 v37, v37, v38
    v_lshlrev_b32 v38, 16, v21
    v_and_b32 v39, 0xffff0000, v21
    v_lshlrev_b32 v40, 16, v29
    v_and_b32 v41, 0xffff0000, v29
    v_mul_f32 v38, v38, v40
    v_mul_f32 v39, v39, v41
    v_cvt_pk_bf16_f32 v38, v38, v39
    v_lshlrev_b32 v39, 16, v38
    v_and_b32 v38, 0xffff0000, v38
    v_add_f32 v37, v37, v39
    v_add_f32 v37, v37, v38
    v_lshlrev_b32 v38, 16, v22
    v_and_b32 v39, 0xffff0000, v22
    v_lshlrev_b32 v40, 16, v30
    v_and_b32 v41, 0xffff0000, v30
    v_mul_f32 v38, v38, v40
    v_mul_f32 v39, v39, v41
    v_cvt_pk_bf16_f32 v38, v38, v39
    v_lshlrev_b32 v39, 16, v38
    v_and_b32 v38, 0xffff0000, v38
    v_add_f32 v37, v37, v39
    v_add_f32 v37, v37, v38
    v_lshlrev_b32 v38, 16, v23
    v_and_b32 v39, 0xffff0000, v23
    v_lshlrev_b32 v40, 16, v31
    v_and_b32 v41, 0xffff0000, v31
    v_mul_f32 v38, v38, v40
    v_mul_f32 v39, v39, v41
    v_cvt_pk_bf16_f32 v38, v38, v39
    v_lshlrev_b32 v39, 16, v38
    v_and_b32 v38, 0xffff0000, v38
    v_add_f32 v37, v37, v39
    v_add_f32 v37, v37, v38
    v_lshlrev_b32 v38, 16, v24
    v_and_b32 v39, 0xffff0000, v24
    v_lshlrev_b32 v40, 16, v32
    v_and_b32 v41, 0xffff0000, v32
    v_mul_f32 v38, v38, v40
    v_mul_f32 v39, v39, v41
    v_cvt_pk_bf16_f32 v38, v38, v39
    v_lshlrev_b32 v39, 16, v38
    v_and_b32 v38, 0xffff0000, v38
    v_add_f32 v37, v37, v39
    v_add_f32 v37, v37, v38
    v_lshlrev_b32 v38, 16, v25
    v_and_b32 v39, 0xffff0000, v25
    v_lshlrev_b32 v40, 16, v33
    v_and_b32 v41, 0xffff0000, v33
    v_mul_f32 v38, v38, v40
    v_mul_f32 v39, v39, v41
    v_cvt_pk_bf16_f32 v38, v38, v39
    v_lshlrev_b32 v39, 16, v38
    v_and_b32 v38, 0xffff0000, v38
    v_add_f32 v37, v37, v39
    v_add_f32 v37, v37, v38
    v_lshlrev_b32 v38, 16, v26
    v_and_b32 v39, 0xffff0000, v26
    v_lshlrev_b32 v40, 16, v34
    v_and_b32 v41, 0xffff0000, v34
    v_mul_f32 v38, v38, v40
    v_mul_f32 v39, v39, v41
    v_cvt_pk_bf16_f32 v38, v38, v39
    v_lshlrev_b32 v39, 16, v38
    v_and_b32 v38, 0xffff0000, v38
    v_add_f32 v37, v37, v39
    v_add_f32 v37, v37, v38
    v_lshlrev_b32 v38, 16, v27
    v_and_b32 v39, 0xffff0000, v27
    v_lshlrev_b32 v40, 16, v35
    v_and_b32 v41, 0xffff0000, v35
    v_mul_f32 v38, v38, v40
    v_mul_f32 v39, v39, v41
    v_cvt_pk_bf16_f32 v38, v38, v39
    v_lshlrev_b32 v39, 16, v38
    v_and_b32 v38, 0xffff0000, v38
    v_add_f32 v37, v37, v39
    v_add_f32 v37, v37, v38
    s_nop 1
    v_add_f32_dpp v37, v37, v37 row_shr:1 row_mask:0xf bank_mask:0xf bound_ctrl:0
    s_nop 1
    v_add_f32_dpp v37, v37, v37 row_shr:2 row_mask:0xf bank_mask:0xf bound_ctrl:0
    s_nop 1
    v_add_f32_dpp v37, v37, v37 row_shr:4 row_mask:0xf bank_mask:0xf bound_ctrl:0
    s_nop 1
    v_add_f32_dpp v37, v37, v37 row_shr:8 row_mask:0xf bank_mask:0xf bound_ctrl:0
    s_nop 1
    v_add_f32_dpp v37, v37, v37 row_bcast:15 row_mask:0xa bank_mask:0xf
    v_cvt_pk_bf16_f32 v37, v37, v37
    v_lshlrev_b32 v37, 16, v37
    v_mul_f32 v37, 0xbfb8aa3b, v37
    v_exp_f32 v37, v37
    s_nop 0
    v_add_f32 v37, 1.0, v37
    v_rcp_f32 v37, v37
    s_nop 0
    v_cvt_pk_bf16_f32 v37, v37, v37
    v_lshlrev_b32 v38, 16, v37
    v_sub_f32 v38, 1.0, v38
    v_cvt_pk_bf16_f32 v38, v38, v38
    v_and_b32 v37, 0xffff, v37
    v_lshl_or_b32 v42, v38, 16, v37
    v_mov_b32 v40, s100
    v_mov_b32 v41, s101
    s_lshl_b32 s40, s2, 7
    s_add_u32 s40, s40, 0x13fff00
    v_lshrrev_b32 v38, 5, v0
    v_lshlrev_b32 v38, 4, v38
    s_mov_b32 exec_lo, 0x80000000
    s_mov_b32 exec_hi, 0x80000000
    buffer_store_dwordx3 v[40:42], v38, s[16:19], s40 offen sc1
    s_mov_b64 exec, -1
    s_mov_b32 s8, s12
    s_and_b32 s9, s13, 0xffff
    s_mov_b32 s10, 0x80000
    s_mov_b32 s11, 0x00020000
    s_lshl_b32 s53, s3, 17
    s_lshl_b32 s54, s3, 13
    v_and_b32 v17, 7, v2
    v_lshlrev_b32 v17, 8, v17
    s_add_u32 m0, s54, 32768
    s_add_u32 s40, s53, 0
    buffer_load_dwordx4 v10, s[8:11], s40 offen lds
    s_add_u32 m0, s54, 33792
    s_add_u32 s40, s53, 8192
    buffer_load_dwordx4 v10, s[8:11], s40 offen lds
    s_sleep 3
    s_add_u32 m0, s54, 34816
    s_add_u32 s40, s53, 32768
    buffer_load_dwordx4 v10, s[8:11], s40 offen lds
    s_add_u32 m0, s54, 35840
    s_add_u32 s40, s53, 40960
    buffer_load_dwordx4 v10, s[8:11], s40 offen lds
    s_sleep 3
    s_add_u32 m0, s54, 36864
    s_add_u32 s40, s53, 65536
    buffer_load_dwordx4 v10, s[8:11], s40 offen lds
    s_add_u32 m0, s54, 37888
    s_add_u32 s40, s53, 73728
    buffer_load_dwordx4 v10, s[8:11], s40 offen lds
    s_sleep 3
    s_add_u32 m0, s54, 38912
    s_add_u32 s40, s53, 98304
    buffer_load_dwordx4 v10, s[8:11], s40 offen lds
    s_add_u32 m0, s54, 39936
    s_add_u32 s40, s53, 106496
    buffer_load_dwordx4 v10, s[8:11], s40 offen lds
    s_sleep 3
KF_TW4:
    ds_read_b32 v18, v17 offset:128
    s_waitcnt lgkmcnt(0)
    v_cmp_eq_u32 vcc, 0, v18
    s_cbranch_vccz KF_TW5
    s_sleep 2
    s_branch KF_TW4
KF_TW5:
    s_add_u32 m0, s54, 131072
    s_add_u32 s40, s53, 16384
    buffer_load_dwordx4 v10, s[8:11], s40 offen lds
    s_add_u32 m0, s54, 132096
    s_add_u32 s40, s53, 24576
    buffer_load_dwordx4 v10, s[8:11], s40 offen lds
    s_sleep 3
    s_add_u32 m0, s54, 133120
    s_add_u32 s40, s53, 49152
    buffer_load_dwordx4 v10, s[8:11], s40 offen lds
    s_add_u32 m0, s54, 134144
    s_add_u32 s40, s53, 57344
    buffer_load_dwordx4 v10, s[8:11], s40 offen lds
    s_sleep 3
    s_add_u32 m0, s54, 135168
    s_add_u32 s40, s53, 81920
    buffer_load_dwordx4 v10, s[8:11], s40 offen lds
    s_add_u32 m0, s54, 136192
    s_add_u32 s40, s53, 90112
    buffer_load_dwordx4 v10, s[8:11], s40 offen lds
    s_sleep 3
    s_add_u32 m0, s54, 137216
    s_add_u32 s40, s53, 114688
    buffer_load_dwordx4 v10, s[8:11], s40 offen lds
    s_add_u32 m0, s54, 138240
    s_add_u32 s40, s53, 122880
    buffer_load_dwordx4 v10, s[8:11], s40 offen lds
    s_sleep 3
    v_and_b32 v17, 15, v2
    v_lshlrev_b32 v17, 3, v17
    v_mov_b32 v18, 0
    v_mov_b32 v11, s57
    s_sub_u32 s50, s96, 1
    s_cmp_lt_u32 s50, 2
    s_cselect_b32 s50, 0, 400
    s_mov_b32 s51, 1024
    s_mov_b32 s55, 0x4000
KF_DPOLL:
    s_cmp_eq_u32 s50, 0
    s_cbranch_scc1 KF_DABORT
    s_sub_u32 s50, s50, 1
    buffer_load_dwordx2 v[12:13], v17, s[16:19], s41 offen sc1
    s_waitcnt vmcnt(0)
    v_subrev_co_u32 v12, vcc, s56, v12
    s_nop 1
    v_subb_co_u32 v13, vcc, v13, v11, vcc
    v_lshrrev_b32 v12, 24, v12
    v_or_b32 v12, v12, v13
    v_cmp_ne_u32 vcc, 0, v12
    s_and_b64 vcc, vcc, s[98:99]
    s_cbranch_vccz KF_DGO
    s_sleep 4
    s_branch KF_DPOLL
KF_DGO:
    v_mov_b32 v12, 17
    ds_write_b32 v15, v12
    buffer_load_dwordx4 v[20:23], v1, s[16:19], s46 offen sc1
    buffer_load_dwordx4 v[24:27], v1, s[16:19], s47 offen sc1
    s_add_u32 s46, s46, s51
    s_add_u32 s47, s47, s51
    buffer_load_dword v19, v18, s[16:19], s41 offen
    buffer_load_dword v19, v18, s[16:19], s41 offen
    s_sleep 6
    buffer_load_dwordx4 v[28:31], v1, s[16:19], s46 offen sc1
    buffer_load_dwordx4 v[32:35], v1, s[16:19], s47 offen sc1
    s_add_u32 s46, s46, s51
    s_add_u32 s47, s47, s51
    buffer_load_dword v19, v18, s[16:19], s41 offen
    buffer_load_dword v19, v18, s[16:19], s41 offen
    s_sleep 6
    buffer_load_dwordx4 v[36:39], v1, s[16:19], s46 offen sc1
    buffer_load_dwordx4 v[40:43], v1, s[16:19], s47 offen sc1
    s_add_u32 s46, s46, s51
    s_add_u32 s47, s47, s51
    buffer_load_dword v19, v18, s[16:19], s41 offen
    buffer_load_dword v19, v18, s[16:19], s41 offen
    s_sleep 6
    buffer_load_dwordx4 v[44:47], v1, s[16:19], s46 offen sc1
    buffer_load_dwordx4 v[48:51], v1, s[16:19], s47 offen sc1
    s_add_u32 s46, s46, s51
    s_add_u32 s47, s47, s51
    buffer_load_dword v19, v18, s[16:19], s41 offen
    buffer_load_dword v19, v18, s[16:19], s41 offen
    s_sleep 6
    buffer_load_dwordx4 v[52:55], v1, s[16:19], s46 offen sc1
    buffer_load_dwordx4 v[56:59], v1, s[16:19], s47 offen sc1
    s_add_u32 s46, s46, s51
    s_add_u32 s47, s47, s51
    buffer_load_dword v19, v18, s[16:19], s41 offen
    buffer_load_dword v19, v18, s[16:19], s41 offen
    s_sleep 6
    buffer_load_dwordx4 v[60:63], v1, s[16:19], s46 offen sc1
    buffer_load_dwordx4 v[64:67], v1, s[16:19], s47 offen sc1
    s_add_u32 s46, s46, s51
    s_add_u32 s47, s47, s51
    buffer_load_dword v19, v18, s[16:19], s41 offen
    buffer_load_dword v19, v18, s[16:19], s41 offen
    s_sleep 6
    buffer_load_dwordx4 v[68:71], v1, s[16:19], s46 offen sc1
    buffer_load_dwordx4 v[72:75], v1, s[16:19], s47 offen sc1
    s_add_u32 s46, s46, s51
    s_add_u32 s47, s47, s51
    buffer_load_dword v19, v18, s[16:19], s41 offen
    buffer_load_dword v19, v18, s[16:19], s41 offen
    s_setprio 3
    s_mov_b32 s50, 0
    s_mov_b64 vcc, -1
KF_DLOOP:
    s_waitcnt vmcnt(24)
    ds_read_b64_tr_b16 v[76:77], v8 offset:0
    ds_read_b64_tr_b16 v[78:79], v8 offset:1024
    ds_read_b64_tr_b16 v[80:81], v9 offset:0
    ds_read_b64_tr_b16 v[82:83], v9 offset:1024
    s_waitcnt lgkmcnt(2)
    v_mfma_f32_32x32x16_bf16 v[92:107], v[76:79], v[20:23], v[92:107]
    s_sleep 2
    v_mfma_f32_32x32x16_bf16 v[108:123], v[76:79], v[24:27], v[108:123]
    s_sleep 2
    s_waitcnt lgkmcnt(0)
    v_mfma_f32_32x32x16_bf16 v[124:139], v[80:83], v[20:23], v[124:139]
    s_sleep 3
    v_mfma_f32_32x32x16_bf16 v[140:155], v[80:83], v[24:27], v[140:155]
    s_cbranch_vccz KF_DS0
    buffer_load_dwordx4 v[20:23], v1, s[16:19], s46 offen sc1
    buffer_load_dwordx4 v[24:27], v1, s[16:19], s47 offen sc1
    s_add_u32 m0, s43, 0
    s_add_u32 s46, s46, s51
    buffer_load_dwordx4 v10, s[28:31], s44 offen lds
    s_add_u32 m0, s43, 1024
    s_add_u32 s47, s47, s51
    buffer_load_dwordx4 v10, s[28:31], s45 offen lds
    s_add_u32 s44, s44, s55
    s_add_u32 s45, s45, s55
KF_DS0:
    s_sleep 2
    s_waitcnt vmcnt(24)
    s_cbranch_vccnz KF_DL1
    s_waitcnt vmcnt(20)
KF_DL1:
    ds_read_b64_tr_b16 v[84:85], v8 offset:2048
    ds_read_b64_tr_b16 v[86:87], v8 offset:3072
    ds_read_b64_tr_b16 v[88:89], v9 offset:2048
    ds_read_b64_tr_b16 v[90:91], v9 offset:3072
    s_waitcnt lgkmcnt(2)
    v_mfma_f32_32x32x16_bf16 v[92:107], v[84:87], v[28:31], v[92:107]
    s_sleep 2
    v_mfma_f32_32x32x16_bf16 v[108:123], v[84:87], v[32:35], v[108:123]
    s_sleep 3
    s_waitcnt lgkmcnt(0)
    v_mfma_f32_32x32x16_bf16 v[124:139], v[88:91], v[28:31], v[124:139]
    s_sleep 2
    v_mfma_f32_32x32x16_bf16 v[140:155], v[88:91], v[32:35], v[140:155]
    s_cbranch_vccz KF_DS1
    buffer_load_dwordx4 v[28:31], v1, s[16:19], s46 offen sc1
    buffer_load_dwordx4 v[32:35], v1, s[16:19], s47 offen sc1
    s_add_u32 m0, s43, 2048
    s_add_u32 s46, s46, s51
    buffer_load_dwordx4 v10, s[28:31], s44 offen lds
    s_add_u32 m0, s43, 3072
    s_add_u32 s47, s47, s51
    buffer_load_dwordx4 v10, s[28:31], s45 offen lds
    s_add_u32 s44, s44, s55
    s_add_u32 s45, s45, s55
KF_DS1:
    s_sleep 2
    s_cbranch_vccnz KF_GD2
    v_subrev_u32 v12, 1024, v15
    s_setprio 2
KF_GD:
    s_sleep 1
    ds_read_b32 v16, v12
    s_waitcnt lgkmcnt(0)
    v_cmp_eq_u32 vcc, 0, v16
    s_cbranch_vccnz KF_GD
KF_GD2:
    s_waitcnt vmcnt(24)
    s_cbranch_vccnz KF_DL2
    s_waitcnt vmcnt(16)
KF_DL2:
    ds_read_b64_tr_b16 v[76:77], v8 offset:4096
    ds_read_b64_tr_b16 v[78:79], v8 offset:5120
    ds_read_b64_tr_b16 v[80:81], v9 offset:4096
    ds_read_b64_tr_b16 v[82:83], v9 offset:5120
    s_waitcnt lgkmcnt(2)
    v_mfma_f32_32x32x16_bf16 v[92:107], v[76:79], v[36:39], v[92:107]
    s_cbranch_vccz KF_GS8
    s_sleep 3
KF_GS8:
    v_mfma_f32_32x32x16_bf16 v[108:123], v[76:79], v[40:43], v[108:123]
    s_cbranch_vccz KF_GS9
    s_sleep 2
KF_GS9:
    s_waitcnt lgkmcnt(0)
    v_mfma_f32_32x32x16_bf16 v[124:139], v[80:83], v[36:39], v[124:139]
    s_cbranch_vccz KF_GS10
    s_sleep 2
KF_GS10:
    v_mfma_f32_32x32x16_bf16 v[140:155], v[80:83], v[40:43], v[140:155]
    s_cbranch_vccz KF_DS2
    buffer_load_dwordx4 v[36:39], v1, s[16:19], s46 offen sc1
    buffer_load_dwordx4 v[40:43], v1, s[16:19], s47 offen sc1
    s_add_u32 m0, s43, 4096
    s_add_u32 s46, s46, s51
    buffer_load_dwordx4 v10, s[28:31], s44 offen lds
    s_add_u32 m0, s43, 5120
    s_add_u32 s47, s47, s51
    buffer_load_dwordx4 v10, s[28:31], s45 offen lds
    s_add_u32 s44, s44, s55
    s_add_u32 s45, s45, s55
KF_DS2:
    s_cbranch_vccz KF_GS11
    s_sleep 3
KF_GS11:
    s_waitcnt vmcnt(24)
    s_cbranch_vccnz KF_DL3
    s_waitcnt vmcnt(12)
KF_DL3:
    ds_read_b64_tr_b16 v[84:85], v8 offset:6144
    ds_read_b64_tr_b16 v[86:87], v8 offset:7168
    ds_read_b64_tr_b16 v[88:89], v9 offset:6144
    ds_read_b64_tr_b16 v[90:91], v9 offset:7168
    s_waitcnt lgkmcnt(2)
    v_mfma_f32_32x32x16_bf16 v[92:107], v[84:87], v[44:47], v[92:107]
    s_cbranch_vccz KF_GS12
    s_sleep 2
KF_GS12:
    v_mfma_f32_32x32x16_bf16 v[108:123], v[84:87], v[48:51], v[108:123]
    s_cbranch_vccz KF_GS13
    s_sleep 2
KF_GS13:
    s_waitcnt lgkmcnt(0)
    v_mfma_f32_32x32x16_bf16 v[124:139], v[88:91], v[44:47], v[124:139]
    s_cbranch_vccz KF_GS14
    s_sleep 3
KF_GS14:
    v_mfma_f32_32x32x16_bf16 v[140:155], v[88:91], v[48:51], v[140:155]
    s_cbranch_vccz KF_DS3
    buffer_load_dwordx4 v[44:47], v1, s[16:19], s46 offen sc1
    buffer_load_dwordx4 v[48:51], v1, s[16:19], s47 offen sc1
    s_add_u32 m0, s43, 6144
    s_add_u32 s46, s46, s51
    buffer_load_dwordx4 v10, s[28:31], s44 offen lds
    s_add_u32 m0, s43, 7168
    s_add_u32 s47, s47, s51
    buffer_load_dwordx4 v10, s[28:31], s45 offen lds
    s_add_u32 s44, s44, s55
    s_add_u32 s45, s45, s55
KF_DS3:
    s_cbranch_vccz KF_GS15
    s_sleep 2
KF_GS15:
    s_waitcnt vmcnt(24)
    s_cbranch_vccnz KF_DL4
    s_waitcnt vmcnt(8)
KF_DL4:
    ds_read_b64_tr_b16 v[76:77], v8 offset:8192
    ds_read_b64_tr_b16 v[78:79], v8 offset:9216
    ds_read_b64_tr_b16 v[80:81], v9 offset:8192
    ds_read_b64_tr_b16 v[82:83], v9 offset:9216
    s_waitcnt lgkmcnt(2)
    v_mfma_f32_32x32x16_bf16 v[92:107], v[76:79], v[52:55], v[92:107]
    s_cbranch_vccz KF_GS16
    s_sleep 2
KF_GS16:
    v_mfma_f32_32x32x16_bf16 v[108:123], v[76:79], v[56:59], v[108:123]
    s_cbranch_vccz KF_GS17
    s_sleep 3
KF_GS17:
    s_waitcnt lgkmcnt(0)
    v_mfma_f32_32x32x16_bf16 v[124:139], v[80:83], v[52:55], v[124:139]
    s_cbranch_vccz KF_GS18
    s_sleep 2
KF_GS18:
    v_mfma_f32_32x32x16_bf16 v[140:155], v[80:83], v[56:59], v[140:155]
    s_cbranch_vccz KF_DS4
    buffer_load_dwordx4 v[52:55], v1, s[16:19], s46 offen sc1
    buffer_load_dwordx4 v[56:59], v1, s[16:19], s47 offen sc1
    s_add_u32 m0, s43, 8192
    s_add_u32 s46, s46, s51
    buffer_load_dwordx4 v10, s[28:31], s44 offen lds
    s_add_u32 m0, s43, 9216
    s_add_u32 s47, s47, s51
    buffer_load_dwordx4 v10, s[28:31], s45 offen lds
    s_add_u32 s44, s44, s55
    s_add_u32 s45, s45, s55
KF_DS4:
    s_cbranch_vccz KF_GS19
    s_sleep 2
KF_GS19:
    s_waitcnt vmcnt(24)
    s_cbranch_vccnz KF_DL5
    s_waitcnt vmcnt(4)
KF_DL5:
    ds_read_b64_tr_b16 v[84:85], v8 offset:10240
    ds_read_b64_tr_b16 v[86:87], v8 offset:11264
    ds_read_b64_tr_b16 v[88:89], v9 offset:10240
    ds_read_b64_tr_b16 v[90:91], v9 offset:11264
    s_waitcnt lgkmcnt(2)
    v_mfma_f32_32x32x16_bf16 v[92:107], v[84:87], v[60:63], v[92:107]
    s_cbranch_vccz KF_GS20
    s_sleep 3
KF_GS20:
    v_mfma_f32_32x32x16_bf16 v[108:123], v[84:87], v[64:67], v[108:123]
    s_cbranch_vccz KF_GS21
    s_sleep 2
KF_GS21:
    s_waitcnt lgkmcnt(0)
    v_mfma_f32_32x32x16_bf16 v[124:139], v[88:91], v[60:63], v[124:139]
    s_cbranch_vccz KF_GS22
    s_sleep 2
KF_GS22:
    v_mfma_f32_32x32x16_bf16 v[140:155], v[88:91], v[64:67], v[140:155]
    s_cbranch_vccz KF_DS5
    buffer_load_dwordx4 v[60:63], v1, s[16:19], s46 offen sc1
    buffer_load_dwordx4 v[64:67], v1, s[16:19], s47 offen sc1
    s_add_u32 m0, s43, 10240
    s_add_u32 s46, s46, s51
    buffer_load_dwordx4 v10, s[28:31], s44 offen lds
    s_add_u32 m0, s43, 11264
    s_add_u32 s47, s47, s51
    buffer_load_dwordx4 v10, s[28:31], s45 offen lds
    s_add_u32 s44, s44, s55
    s_add_u32 s45, s45, s55
KF_DS5:
    s_cbranch_vccz KF_GS23
    s_sleep 3
KF_GS23:
    s_waitcnt vmcnt(24)
    s_cbranch_vccnz KF_DL6
    s_waitcnt vmcnt(0)
KF_DL6:
    ds_read_b64_tr_b16 v[76:77], v8 offset:12288
    ds_read_b64_tr_b16 v[78:79], v8 offset:13312
    ds_read_b64_tr_b16 v[80:81], v9 offset:12288
    ds_read_b64_tr_b16 v[82:83], v9 offset:13312
    s_waitcnt lgkmcnt(2)
    v_mfma_f32_32x32x16_bf16 v[92:107], v[76:79], v[68:71], v[92:107]
    s_cbranch_vccz KF_GS24
    s_sleep 2
KF_GS24:
    v_mfma_f32_32x32x16_bf16 v[108:123], v[76:79], v[72:75], v[108:123]
    s_cbranch_vccz KF_GS25
    s_sleep 2
KF_GS25:
    s_waitcnt lgkmcnt(0)
    v_mfma_f32_32x32x16_bf16 v[124:139], v[80:83], v[68:71], v[124:139]
    s_cbranch_vccz KF_GS26
    s_sleep 3
KF_GS26:
    v_mfma_f32_32x32x16_bf16 v[140:155], v[80:83], v[72:75], v[140:155]
    s_cmp_lt_u32 s50, 2
    s_cselect_b32 s51, 1024, 0
    s_lshl_b32 s55, s51, 4
    s_cbranch_vccz KF_DS6
    buffer_load_dwordx4 v[68:71], v1, s[16:19], s46 offen sc1
    buffer_load_dwordx4 v[72:75], v1, s[16:19], s47 offen sc1
    s_add_u32 m0, s43, 12288
    s_add_u32 s46, s46, s51
    buffer_load_dwordx4 v10, s[28:31], s44 offen lds
    s_add_u32 m0, s43, 13312
    s_add_u32 s47, s47, s51
    buffer_load_dwordx4 v10, s[28:31], s45 offen lds
    s_add_u32 s44, s44, s55
    s_add_u32 s45, s45, s55
KF_DS6:
    s_cbranch_vccz KF_GS27
    s_sleep 2
KF_GS27:
    s_add_u32 s50, s50, 1
    s_cmp_lt_u32 s50, 3
    s_cselect_b64 vcc, -1, 0
    s_cmp_lt_u32 s50, 4
    s_cbranch_scc1 KF_DLOOP
    s_setprio 2
    s_waitcnt vmcnt(0)
    v_add_u32 v8, s43, v1
    v_add_u32 v9, 65536, v1
    s_lshl_b32 s44, s3, 12
    v_add_u32 v9, s44, v9
    ds_write_b128 v8, v[92:95] offset:0
    ds_write_b128 v8, v[96:99] offset:1024
    ds_write_b128 v8, v[100:103] offset:2048
    ds_write_b128 v8, v[104:107] offset:3072
    ds_write_b128 v8, v[108:111] offset:4096
    ds_write_b128 v8, v[112:115] offset:5120
    ds_write_b128 v8, v[116:119] offset:6144
    ds_write_b128 v8, v[120:123] offset:7168
    ds_write_b128 v8, v[124:127] offset:8192
    ds_write_b128 v8, v[128:131] offset:9216
    ds_write_b128 v8, v[132:135] offset:10240
    ds_write_b128 v8, v[136:139] offset:11264
    ds_write_b128 v8, v[140:143] offset:12288
    ds_write_b128 v8, v[144:147] offset:13312
    ds_write_b128 v8, v[148:151] offset:14336
    ds_write_b128 v8, v[152:155] offset:15360
    v_mov_b32 v17, 18
    s_waitcnt lgkmcnt(0)
    ds_write_b32 v15, v17
KF_DW2:
    s_sleep 1
    ds_read_b32 v16, v14
    s_waitcnt lgkmcnt(0)
    v_cmp_gt_u32 vcc, 18, v16
    s_cbranch_vccnz KF_DW2
    v_cmp_lt_u32 vcc, 18, v16
    s_cbranch_vccnz KF_GAB
    ds_read_b128 v[92:95], v9 offset:0
    ds_read_b128 v[96:99], v9 offset:1024
    ds_read_b128 v[100:103], v9 offset:2048
    ds_read_b128 v[104:107], v9 offset:3072
    ds_read_b128 v[108:111], v9 offset:16384
    ds_read_b128 v[112:115], v9 offset:17408
    ds_read_b128 v[116:119], v9 offset:18432
    ds_read_b128 v[120:123], v9 offset:19456
    ds_read_b128 v[124:127], v9 offset:32768
    ds_read_b128 v[128:131], v9 offset:33792
    ds_read_b128 v[132:135], v9 offset:34816
    ds_read_b128 v[136:139], v9 offset:35840
    ds_read_b128 v[140:143], v9 offset:49152
    ds_read_b128 v[144:147], v9 offset:50176
    ds_read_b128 v[148:151], v9 offset:51200
    ds_read_b128 v[152:155], v9 offset:52224
    s_waitcnt lgkmcnt(8)
    v_pk_add_f32 v[92:93], v[92:93], v[108:109]
    v_pk_add_f32 v[94:95], v[94:95], v[110:111]
    v_pk_add_f32 v[96:97], v[96:97], v[112:113]
    v_pk_add_f32 v[98:99], v[98:99], v[114:115]
    v_pk_add_f32 v[100:101], v[100:101], v[116:117]
    v_pk_add_f32 v[102:103], v[102:103], v[118:119]
    v_pk_add_f32 v[104:105], v[104:105], v[120:121]
    v_pk_add_f32 v[106:107], v[106:107], v[122:123]
    s_waitcnt lgkmcnt(0)
    v_pk_add_f32 v[124:125], v[124:125], v[140:141]
    v_pk_add_f32 v[126:127], v[126:127], v[142:143]
    v_pk_add_f32 v[128:129], v[128:129], v[144:145]
    v_pk_add_f32 v[130:131], v[130:131], v[146:147]
    v_pk_add_f32 v[132:133], v[132:133], v[148:149]
    v_pk_add_f32 v[134:135], v[134:135], v[150:151]
    v_pk_add_f32 v[136:137], v[136:137], v[152:153]
    v_pk_add_f32 v[138:139], v[138:139], v[154:155]
    v_pk_add_f32 v[92:93], v[92:93], v[124:125]
    v_pk_add_f32 v[94:95], v[94:95], v[126:127]
    v_pk_add_f32 v[96:97], v[96:97], v[128:129]
    v_pk_add_f32 v[98:99], v[98:99], v[130:131]
    v_pk_add_f32 v[100:101], v[100:101], v[132:133]
    v_pk_add_f32 v[102:103], v[102:103], v[134:135]
    v_pk_add_f32 v[104:105], v[104:105], v[136:137]
    v_pk_add_f32 v[106:107], v[106:107], v[138:139]
    v_cvt_pk_bf16_f32 v20, v92, v93
    v_cvt_pk_bf16_f32 v21, v94, v95
    v_cvt_pk_bf16_f32 v22, v96, v97
    v_cvt_pk_bf16_f32 v23, v98, v99
    v_cvt_pk_bf16_f32 v24, v100, v101
    v_cvt_pk_bf16_f32 v25, v102, v103
    v_cvt_pk_bf16_f32 v26, v104, v105
    v_cvt_pk_bf16_f32 v27, v106, v107
    ds_write_b128 v9, v[20:23] offset:32768
    ds_write_b128 v9, v[24:27] offset:33792
    v_mov_b32 v17, 2
    s_waitcnt lgkmcnt(0)
    ds_write_b32 v15, v17 offset:1024
    s_branch KF_FIN
KF_END:
    s_endpgm
KF_DABORT:
    v_mov_b32 v17, 0x1000
    s_waitcnt vmcnt(0)
    ds_write_b32 v15, v17
KF_GAB:
    v_mov_b32 v17, 3
    ds_write_b32 v15, v17 offset:1024
    s_branch KF_FIN
KF_CMP:
    s_and_b32 s36, s3, 3
    s_lshr_b32 s37, s3, 2
    s_cmp_eq_u32 s46, 0
    s_cselect_b32 s24, 98304, 0
    s_cselect_b32 s25, 0, 65536
    s_waitcnt lgkmcnt(0)
    s_mov_b64 s[100:101], s[56:57]
    s_mov_b32 s16, s14
    s_and_b32 s17, s15, 0xffff
    s_mov_b32 s18, 0x1600000
    s_mov_b32 s19, 0x00020000
    s_lshl_b32 s38, s35, 2
    s_add_u32 s38, s38, s36
    s_lshl_b32 s58, s34, 1
    s_add_u32 s58, s58, s37
    s_lshr_b32 s43, s38, 1
    s_lshl_b32 s55, s43, 9
    s_lshl_b32 s59, s38, 8
    s_lshl_b32 s49, s37, 7
    s_add_u32 s59, s59, s49
    s_lshl_b32 s49, s34, 3
    s_add_u32 s59, s59, s49
    s_add_u32 s59, s59, 0x1414000
    s_and_b32 s49, s38, 1
    s_lshl_b32 s49, s49, 4
    s_add_u32 s55, s55, s49
    s_lshl_b32 s49, s34, 5
    s_add_u32 s55, s55, s49
    s_lshl_b32 s49, s37, 3
    s_add_u32 s55, s55, s49
    s_add_u32 s55, s55, 0x1418000
    v_lshlrev_b32 v167, 7, v2
    s_mov_b32 s10, 6144
    s_mov_b32 s8, s6
    s_mov_b32 s9, s7
    s_cmp_eq_u32 s3, 1
    s_cselect_b32 s10, 7168, s10
    s_cselect_b32 s8, s88, s8
    s_cselect_b32 s9, s89, s9
    s_cmp_eq_u32 s3, 2
    s_cselect_b32 s10, 7168, s10
    s_cselect_b32 s8, s90, s8
    s_cselect_b32 s9, s91, s9
    s_cmp_eq_u32 s3, 3
    s_cselect_b32 s10, 7168, s10
    s_cselect_b32 s8, s92, s8
    s_cselect_b32 s9, s93, s9
    s_mul_i32 s48, s10, s2
    s_add_u32 s8, s8, s48
    s_addc_u32 s9, s9, 0
    s_cmp_gt_u32 s3, 3
    s_cselect_b32 s10, 0, s10
    s_and_b32 s9, s9, 0xffff
    s_mov_b32 s11, 0x00020000
    buffer_load_dword v167, v167, s[8:11], 0 offen
    v_and_b32 v5, 31, v2
    v_lshrrev_b32 v4, 5, v2
    v_bfe_u32 v7, v2, 1, 3
    v_xor_b32 v7, v7, v4
    v_lshlrev_b32 v7, 4, v7
    v_lshl_add_u32 v7, v5, 7, v7
    s_lshl_b32 s48, s36, 12
    s_add_u32 s49, s48, s24
    s_add_u32 s48, s48, s25
    v_add_u32 v16, s49, v7
    v_add_u32 v20, s48, v7
    v_xor_b32 v17, 32, v16
    v_xor_b32 v18, 64, v16
    v_xor_b32 v19, 0x60, v16
    v_xor_b32 v21, 32, v20
    v_xor_b32 v22, 64, v20
    v_xor_b32 v23, 0x60, v20
    v_bfe_u32 v5, v2, 2, 2
    v_lshl_add_u32 v4, v4, 3, v5
    v_lshlrev_b32 v4, 7, v4
    v_and_b32 v5, 3, v2
    v_lshl_add_u32 v4, v5, 3, v4
    v_and_b32 v5, 8, v2
    v_lshl_add_u32 v4, v5, 3, v4
    v_bfe_u32 v7, v2, 4, 1
    v_xor_b32 v3, s37, v7
    v_lshl_add_u32 v5, v3, 5, v4
    v_lshl_add_u32 v5, v7, 14, v5
    v_lshl_add_u32 v4, v7, 5, v4
    s_lshl_b32 s48, s37, 6
    v_xor_b32 v4, s48, v4
    s_cmp_eq_u32 s46, 0
    s_cselect_b32 s48, 32768, s25
    s_cselect_b32 s49, 0, 32768
    s_add_u32 s48, s48, s49
    s_cmp_eq_u32 s46, 0
    s_cselect_b32 s49, 131072, s49
    v_add_u32 v2, s48, v4
    v_add_u32 v3, s49, v4
    v_mov_b32 v6, s56
    v_mov_b32 v7, s57
    s_sub_u32 s12, s56, 1600
    s_subb_u32 s13, s57, 0
    s_andn2_b32 s47, s34, 1
    s_add_u32 s47, s47, s37
    s_lshl_b32 s41, s47, 17
    s_lshl_b32 s48, s38, 10
    s_add_u32 s61, s41, s48
    s_lshl_b32 s48, s46, 21
    s_add_u32 s41, s61, s48
    s_add_u32 s41, s41, 0x200000
    s_lshl_b32 s42, s47, 10
    s_lshl_b32 s48, s36, 8
    s_add_u32 s42, s42, s48
    s_lshl_b32 s48, s35, 4
    s_add_u32 s42, s42, s48
    s_lshl_b32 s48, s46, 3
    s_add_u32 s42, s42, s48
    s_add_u32 s42, s42, 0x1410000
    s_lshl_b32 s30, s47, 4
    s_add_u32 s30, s30, s35
    s_lshl_b32 s30, s30, 2
    s_add_u32 s30, s30, s36
    s_lshl_b32 s30, s30, 3
    s_add_u32 s30, s30, 0x141c000
    s_lshr_b32 s48, s34, 2
    s_mul_i32 s48, s48, 28
    s_mul_i32 s43, s38, 112
    s_add_u32 s43, s43, s48
    s_add_u32 s43, s43, s37
    s_bfe_u32 s26, s34, 0x10001
    s_lshl_b32 s48, s26, 3
    s_add_u32 s48, s48, s43
    s_add_u32 s47, s48, 2
    s_lshl_b32 s49, s26, 2
    s_add_u32 s49, s49, s43
    s_add_u32 s49, s49, 16
    s_lshl_b32 s53, s26, 1
    s_add_u32 s43, s43, s53
    s_add_u32 s43, s43, 24
    s_lshl_b32 s26, s26, 6
    s_cmp_eq_u32 s46, 0
    s_cselect_b32 s43, s43, s48
    s_cselect_b32 s49, s49, s47
    s_cselect_b32 s30, s30, s42
    s_cselect_b32 s26, s26, 64
    s_cselect_b32 s24, 0x32, 8
    s_or_b32 s24, s24, 0x42086400
    s_mov_b32 s25, 0x4286
    s_or_b32 s26, s26, 0x400000
    s_lshl_b32 s43, s43, 10
    s_lshl_b32 s49, s49, 10
    s_add_u32 s43, s43, 0x800000
    s_add_u32 s49, s49, 0x800000
    s_mov_b32 s44, 0x3eb8aa3b
    s_mov_b32 s45, 0x3eb8aa3b
    s_lshl_b32 s50, s58, 16
    s_lshl_b32 s48, s36, 10
    s_add_u32 s50, s50, s48
    s_add_u32 s51, s50, 0x400000
    s_add_u32 s50, s50, 0x200000
    s_lshl_b32 s52, s35, 12
    s_cmp_lg_u32 s46, 0
    s_cbranch_scc1 KF_T0B
    s_barrier
    ds_read_b64_tr_b16 v[8:9], v2 offset:0
    ds_read_b64_tr_b16 v[10:11], v2 offset:512
    ds_read_b128 v[40:43], v16 offset:0
    ds_read_b128 v[44:47], v17 offset:0
    ds_read_b64_tr_b16 v[12:13], v2 offset:2048
    ds_read_b64_tr_b16 v[14:15], v2 offset:2560
    ds_read_b128 v[48:51], v18 offset:0
    ds_read_b128 v[52:55], v19 offset:0
    ds_read_b128 v[56:59], v16 offset:16384
    ds_read_b128 v[60:63], v17 offset:16384
    ds_read_b128 v[64:67], v18 offset:16384
    ds_read_b128 v[68:71], v19 offset:16384
    s_waitcnt lgkmcnt(9)
    v_mfma_f32_32x32x16_bf16 v[24:39], v[8:11], v[40:43], 0
    ds_read_b64_tr_b16 v[8:9], v2 offset:4096
    ds_read_b64_tr_b16 v[10:11], v2 offset:4608
    s_waitcnt lgkmcnt(8)
    v_mfma_f32_32x32x16_bf16 v[24:39], v[12:15], v[44:47], v[24:39]
    ds_read_b64_tr_b16 v[12:13], v2 offset:6144
    ds_read_b64_tr_b16 v[14:15], v2 offset:6656
    s_waitcnt lgkmcnt(2)
    v_mfma_f32_32x32x16_bf16 v[24:39], v[8:11], v[48:51], v[24:39]
    ds_read_b64_tr_b16 v[8:9], v2 offset:8192
    ds_read_b64_tr_b16 v[10:11], v2 offset:8704
    s_waitcnt lgkmcnt(2)
    v_mfma_f32_32x32x16_bf16 v[24:39], v[12:15], v[52:55], v[24:39]
    ds_read_b64_tr_b16 v[12:13], v2 offset:10240
    ds_read_b64_tr_b16 v[14:15], v2 offset:10752
    s_waitcnt lgkmcnt(2)
    v_mfma_f32_32x32x16_bf16 v[24:39], v[8:11], v[56:59], v[24:39]
    ds_read_b64_tr_b16 v[8:9], v2 offset:12288
    ds_read_b64_tr_b16 v[10:11], v2 offset:12800
    s_waitcnt lgkmcnt(2)
    v_mfma_f32_32x32x16_bf16 v[24:39], v[12:15], v[60:63], v[24:39]
    ds_read_b64_tr_b16 v[12:13], v2 offset:14336
    ds_read_b64_tr_b16 v[14:15], v2 offset:14848
    s_waitcnt lgkmcnt(2)
    v_mfma_f32_32x32x16_bf16 v[24:39], v[8:11], v[64:67], v[24:39]
    s_waitcnt lgkmcnt(0)
    v_mfma_f32_32x32x16_bf16 v[24:39], v[12:15], v[68:71], v[24:39]
    s_barrier
    ds_read_b64_tr_b16 v[8:9], v2 offset:16384
    ds_read_b64_tr_b16 v[10:11], v2 offset:16896
    ds_read_b128 v[72:75], v20 offset:0
    ds_read_b128 v[76:79], v21 offset:0
    ds_read_b64_tr_b16 v[12:13], v2 offset:18432
    ds_read_b64_tr_b16 v[14:15], v2 offset:18944
    ds_read_b128 v[80:83], v22 offset:0
    ds_read_b128 v[84:87], v23 offset:0
    ds_read_b128 v[88:91], v20 offset:16384
    ds_read_b128 v[92:95], v21 offset:16384
    ds_read_b128 v[96:99], v22 offset:16384
    ds_read_b128 v[100:103], v23 offset:16384
    s_waitcnt lgkmcnt(9)
    v_mfma_f32_32x32x16_bf16 v[24:39], v[8:11], v[72:75], v[24:39]
    ds_read_b64_tr_b16 v[8:9], v2 offset:20480
    ds_read_b64_tr_b16 v[10:11], v2 offset:20992
    v_add_u32 v20, 65536, v20
    s_waitcnt lgkmcnt(8)
    v_mfma_f32_32x32x16_bf16 v[24:39], v[12:15], v[76:79], v[24:39]
    ds_read_b64_tr_b16 v[12:13], v2 offset:22528
    ds_read_b64_tr_b16 v[14:15], v2 offset:23040
    v_add_u32 v21, 65536, v21
    s_waitcnt lgkmcnt(2)
    v_mfma_f32_32x32x16_bf16 v[24:39], v[8:11], v[80:83], v[24:39]
    ds_read_b64_tr_b16 v[8:9], v2 offset:24576
    ds_read_b64_tr_b16 v[10:11], v2 offset:25088
    v_add_u32 v22, 65536, v22
    s_waitcnt lgkmcnt(2)
    v_mfma_f32_32x32x16_bf16 v[24:39], v[12:15], v[84:87], v[24:39]
    ds_read_b64_tr_b16 v[12:13], v2 offset:26624
    ds_read_b64_tr_b16 v[14:15], v2 offset:27136
    v_add_u32 v23, 65536, v23
    s_waitcnt lgkmcnt(2)
    v_mfma_f32_32x32x16_bf16 v[24:39], v[8:11], v[88:91], v[24:39]
    ds_read_b64_tr_b16 v[8:9], v2 offset:28672
    ds_read_b64_tr_b16 v[10:11], v2 offset:29184
    s_waitcnt lgkmcnt(2)
    v_mfma_f32_32x32x16_bf16 v[24:39], v[12:15], v[92:95], v[24:39]
    ds_read_b64_tr_b16 v[12:13], v2 offset:30720
    ds_read_b64_tr_b16 v[14:15], v2 offset:31232
    s_waitcnt lgkmcnt(2)
    v_mfma_f32_32x32x16_bf16 v[24:39], v[8:11], v[96:99], v[24:39]
    s_waitcnt lgkmcnt(0)
    v_mfma_f32_32x32x16_bf16 v[24:39], v[12:15], v[100:103], v[24:39]
    s_barrier
    ds_read_b64_tr_b16 v[8:9], v3 offset:0
    ds_read_b64_tr_b16 v[10:11], v3 offset:512
    ds_read_b128 v[104:107], v20 offset:0
    ds_read_b128 v[108:111], v21 offset:0
    ds_read_b64_tr_b16 v[12:13], v3 offset:2048
    ds_read_b64_tr_b16 v[14:15], v3 offset:2560
    ds_read_b128 v[112:115], v22 offset:0
    ds_read_b128 v[116:119], v23 offset:0
    ds_read_b128 v[120:123], v20 offset:16384
    ds_read_b128 v[124:127], v21 offset:16384
    ds_read_b128 v[128:131], v22 offset:16384
    ds_read_b128 v[132:135], v23 offset:16384
    s_waitcnt lgkmcnt(9)
    v_mfma_f32_32x32x16_bf16 v[24:39], v[8:11], v[104:107], v[24:39]
    ds_read_b64_tr_b16 v[8:9], v3 offset:4096
    ds_read_b64_tr_b16 v[10:11], v3 offset:4608
    s_waitcnt lgkmcnt(8)
    v_mfma_f32_32x32x16_bf16 v[24:39], v[12:15], v[108:111], v[24:39]
    ds_read_b64_tr_b16 v[12:13], v3 offset:6144
    ds_read_b64_tr_b16 v[14:15], v3 offset:6656
    v_mov_b32 v2, v4
    s_waitcnt lgkmcnt(2)
    v_mfma_f32_32x32x16_bf16 v[24:39], v[8:11], v[112:115], v[24:39]
    ds_read_b64_tr_b16 v[8:9], v3 offset:8192
    ds_read_b64_tr_b16 v[10:11], v3 offset:8704
    s_waitcnt lgkmcnt(2)
    v_mfma_f32_32x32x16_bf16 v[24:39], v[12:15], v[116:119], v[24:39]
    ds_read_b64_tr_b16 v[12:13], v3 offset:10240
    ds_read_b64_tr_b16 v[14:15], v3 offset:10752
    s_waitcnt lgkmcnt(2)
    v_mfma_f32_32x32x16_bf16 v[24:39], v[8:11], v[120:123], v[24:39]
    ds_read_b64_tr_b16 v[8:9], v3 offset:12288
    ds_read_b64_tr_b16 v[10:11], v3 offset:12800
    s_waitcnt lgkmcnt(2)
    v_mfma_f32_32x32x16_bf16 v[24:39], v[12:15], v[124:127], v[24:39]
    ds_read_b64_tr_b16 v[12:13], v3 offset:14336
    ds_read_b64_tr_b16 v[14:15], v3 offset:14848
    s_waitcnt lgkmcnt(2)
    v_mfma_f32_32x32x16_bf16 v[24:39], v[8:11], v[128:131], v[24:39]
    s_waitcnt lgkmcnt(0)
    v_mfma_f32_32x32x16_bf16 v[24:39], v[12:15], v[132:135], v[24:39]
    s_waitcnt vmcnt(0)
    s_barrier
    ds_read_b64_tr_b16 v[8:9], v3 offset:16384
    ds_read_b64_tr_b16 v[10:11], v3 offset:16896
    ds_read_b128 v[136:139], v16 offset:0
    ds_read_b128 v[140:143], v17 offset:0
    ds_read_b64_tr_b16 v[12:13], v3 offset:18432
    ds_read_b64_tr_b16 v[14:15], v3 offset:18944
    ds_read_b128 v[144:147], v18 offset:0
    ds_read_b128 v[148:151], v19 offset:0
    ds_read_b128 v[152:155], v16 offset:16384
    ds_read_b128 v[156:159], v17 offset:16384
    ds_read_b128 v[160:163], v18 offset:16384
    ds_read_b128 v[164:167], v19 offset:16384
    s_waitcnt lgkmcnt(9)
    v_mfma_f32_32x32x16_bf16 v[24:39], v[8:11], v[136:139], v[24:39]
    ds_read_b64_tr_b16 v[8:9], v3 offset:20480
    ds_read_b64_tr_b16 v[10:11], v3 offset:20992
    s_waitcnt lgkmcnt(8)
    v_mfma_f32_32x32x16_bf16 v[24:39], v[12:15], v[140:143], v[24:39]
    ds_read_b64_tr_b16 v[12:13], v3 offset:22528
    ds_read_b64_tr_b16 v[14:15], v3 offset:23040
    s_waitcnt lgkmcnt(2)
    v_mfma_f32_32x32x16_bf16 v[24:39], v[8:11], v[144:147], v[24:39]
    ds_read_b64_tr_b16 v[8:9], v3 offset:24576
    ds_read_b64_tr_b16 v[10:11], v3 offset:25088
    s_waitcnt lgkmcnt(2)
    v_mfma_f32_32x32x16_bf16 v[24:39], v[12:15], v[148:151], v[24:39]
    ds_read_b64_tr_b16 v[12:13], v3 offset:26624
    ds_read_b64_tr_b16 v[14:15], v3 offset:27136
    s_barrier
    s_waitcnt lgkmcnt(2)
    v_mfma_f32_32x32x16_bf16 v[24:39], v[8:11], v[152:155], v[24:39]
    ds_read_b64_tr_b16 v[8:9], v3 offset:28672
    ds_read_b64_tr_b16 v[10:11], v3 offset:29184
    s_waitcnt lgkmcnt(2)
    v_mfma_f32_32x32x16_bf16 v[24:39], v[12:15], v[156:159], v[24:39]
    ds_read_b64_tr_b16 v[12:13], v3 offset:30720
    ds_read_b64_tr_b16 v[14:15], v3 offset:31232
    ds_read_b64_tr_b16 v[16:17], v2 offset:4096
    ds_read_b64_tr_b16 v[18:19], v2 offset:4608
    s_waitcnt lgkmcnt(4)
    v_mfma_f32_32x32x16_bf16 v[24:39], v[8:11], v[160:163], v[24:39]
    ds_read_b64_tr_b16 v[8:9], v2 offset:0
    ds_read_b64_tr_b16 v[10:11], v2 offset:512
    v_add_u32 v3, 16384, v4
    s_waitcnt lgkmcnt(4)
    v_mfma_f32_32x32x16_bf16 v[24:39], v[12:15], v[164:167], v[24:39]
    ds_read_b64_tr_b16 v[12:13], v2 offset:2048
    ds_read_b64_tr_b16 v[14:15], v2 offset:2560
    s_add_u32 s48, s41, 0x10000
    s_nop 8
    v_cvt_pk_bf16_f32 v24, v24, v25
    v_cvt_pk_bf16_f32 v25, v26, v27
    v_cvt_pk_bf16_f32 v26, v28, v29
    v_cvt_pk_bf16_f32 v27, v30, v31
    buffer_store_dwordx4 v[24:27], v1, s[16:19], s41 offen sc1
    v_cvt_pk_bf16_f32 v28, v32, v33
    v_cvt_pk_bf16_f32 v29, v34, v35
    v_cvt_pk_bf16_f32 v30, v36, v37
    v_cvt_pk_bf16_f32 v31, v38, v39
    buffer_store_dwordx4 v[28:31], v1, s[16:19], s48 offen sc1
    s_waitcnt lgkmcnt(0)
    s_branch KF_TL
KF_T0B:
    s_barrier
    ds_read_b64_tr_b16 v[8:9], v2 offset:0
    ds_read_b64_tr_b16 v[10:11], v2 offset:512
    ds_read_b128 v[40:43], v16 offset:0
    ds_read_b128 v[44:47], v17 offset:0
    ds_read_b64_tr_b16 v[12:13], v2 offset:2048
    ds_read_b64_tr_b16 v[14:15], v2 offset:2560
    ds_read_b128 v[48:51], v18 offset:0
    ds_read_b128 v[52:55], v19 offset:0
    ds_read_b128 v[56:59], v16 offset:16384
    ds_read_b128 v[60:63], v17 offset:16384
    ds_read_b128 v[64:67], v18 offset:16384
    ds_read_b128 v[68:71], v19 offset:16384
    s_waitcnt lgkmcnt(9)
    v_mfma_f32_32x32x16_bf16 v[24:39], v[40:43], v[8:11], 0
    ds_read_b64_tr_b16 v[8:9], v2 offset:4096
    ds_read_b64_tr_b16 v[10:11], v2 offset:4608
    s_waitcnt lgkmcnt(8)
    v_mfma_f32_32x32x16_bf16 v[24:39], v[44:47], v[12:15], v[24:39]
    ds_read_b64_tr_b16 v[12:13], v2 offset:6144
    ds_read_b64_tr_b16 v[14:15], v2 offset:6656
    s_waitcnt lgkmcnt(2)
    v_mfma_f32_32x32x16_bf16 v[24:39], v[48:51], v[8:11], v[24:39]
    ds_read_b64_tr_b16 v[8:9], v2 offset:8192
    ds_read_b64_tr_b16 v[10:11], v2 offset:8704
    s_waitcnt lgkmcnt(2)
    v_mfma_f32_32x32x16_bf16 v[24:39], v[52:55], v[12:15], v[24:39]
    ds_read_b64_tr_b16 v[12:13], v2 offset:10240
    ds_read_b64_tr_b16 v[14:15], v2 offset:10752
    s_waitcnt lgkmcnt(2)
    v_mfma_f32_32x32x16_bf16 v[24:39], v[56:59], v[8:11], v[24:39]
    ds_read_b64_tr_b16 v[8:9], v2 offset:12288
    ds_read_b64_tr_b16 v[10:11], v2 offset:12800
    s_waitcnt lgkmcnt(2)
    v_mfma_f32_32x32x16_bf16 v[24:39], v[60:63], v[12:15], v[24:39]
    ds_read_b64_tr_b16 v[12:13], v2 offset:14336
    ds_read_b64_tr_b16 v[14:15], v2 offset:14848
    s_waitcnt lgkmcnt(2)
    v_mfma_f32_32x32x16_bf16 v[24:39], v[64:67], v[8:11], v[24:39]
    s_waitcnt lgkmcnt(0)
    v_mfma_f32_32x32x16_bf16 v[24:39], v[68:71], v[12:15], v[24:39]
    s_barrier
    ds_read_b64_tr_b16 v[8:9], v2 offset:16384
    ds_read_b64_tr_b16 v[10:11], v2 offset:16896
    ds_read_b128 v[72:75], v20 offset:0
    ds_read_b128 v[76:79], v21 offset:0
    ds_read_b64_tr_b16 v[12:13], v2 offset:18432
    ds_read_b64_tr_b16 v[14:15], v2 offset:18944
    ds_read_b128 v[80:83], v22 offset:0
    ds_read_b128 v[84:87], v23 offset:0
    ds_read_b128 v[88:91], v20 offset:16384
    ds_read_b128 v[92:95], v21 offset:16384
    ds_read_b128 v[96:99], v22 offset:16384
    ds_read_b128 v[100:103], v23 offset:16384
    s_waitcnt lgkmcnt(9)
    v_mfma_f32_32x32x16_bf16 v[24:39], v[72:75], v[8:11], v[24:39]
    ds_read_b64_tr_b16 v[8:9], v2 offset:20480
    ds_read_b64_tr_b16 v[10:11], v2 offset:20992
    v_add_u32 v20, 65536, v20
    s_waitcnt lgkmcnt(8)
    v_mfma_f32_32x32x16_bf16 v[24:39], v[76:79], v[12:15], v[24:39]
    ds_read_b64_tr_b16 v[12:13], v2 offset:22528
    ds_read_b64_tr_b16 v[14:15], v2 offset:23040
    v_add_u32 v21, 65536, v21
    s_waitcnt lgkmcnt(2)
    v_mfma_f32_32x32x16_bf16 v[24:39], v[80:83], v[8:11], v[24:39]
    ds_read_b64_tr_b16 v[8:9], v2 offset:24576
    ds_read_b64_tr_b16 v[10:11], v2 offset:25088
    v_add_u32 v22, 65536, v22
    s_waitcnt lgkmcnt(2)
    v_mfma_f32_32x32x16_bf16 v[24:39], v[84:87], v[12:15], v[24:39]
    ds_read_b64_tr_b16 v[12:13], v2 offset:26624
    ds_read_b64_tr_b16 v[14:15], v2 offset:27136
    v_add_u32 v23, 65536, v23
    s_waitcnt lgkmcnt(2)
    v_mfma_f32_32x32x16_bf16 v[24:39], v[88:91], v[8:11], v[24:39]
    ds_read_b64_tr_b16 v[8:9], v2 offset:28672
    ds_read_b64_tr_b16 v[10:11], v2 offset:29184
    s_waitcnt lgkmcnt(2)
    v_mfma_f32_32x32x16_bf16 v[24:39], v[92:95], v[12:15], v[24:39]
    ds_read_b64_tr_b16 v[12:13], v2 offset:30720
    ds_read_b64_tr_b16 v[14:15], v2 offset:31232
    s_waitcnt lgkmcnt(2)
    v_mfma_f32_32x32x16_bf16 v[24:39], v[96:99], v[8:11], v[24:39]
    s_waitcnt lgkmcnt(0)
    v_mfma_f32_32x32x16_bf16 v[24:39], v[100:103], v[12:15], v[24:39]
    s_barrier
    ds_read_b64_tr_b16 v[8:9], v3 offset:0
    ds_read_b64_tr_b16 v[10:11], v3 offset:512
    ds_read_b128 v[104:107], v20 offset:0
    ds_read_b128 v[108:111], v21 offset:0
    ds_read_b64_tr_b16 v[12:13], v3 offset:2048
    ds_read_b64_tr_b16 v[14:15], v3 offset:2560
    ds_read_b128 v[112:115], v22 offset:0
    ds_read_b128 v[116:119], v23 offset:0
    ds_read_b128 v[120:123], v20 offset:16384
    ds_read_b128 v[124:127], v21 offset:16384
    ds_read_b128 v[128:131], v22 offset:16384
    ds_read_b128 v[132:135], v23 offset:16384
    s_waitcnt lgkmcnt(9)
    v_mfma_f32_32x32x16_bf16 v[24:39], v[104:107], v[8:11], v[24:39]
    ds_read_b64_tr_b16 v[8:9], v3 offset:4096
    ds_read_b64_tr_b16 v[10:11], v3 offset:4608
    s_waitcnt lgkmcnt(8)
    v_mfma_f32_32x32x16_bf16 v[24:39], v[108:111], v[12:15], v[24:39]
    ds_read_b64_tr_b16 v[12:13], v3 offset:6144
    ds_read_b64_tr_b16 v[14:15], v3 offset:6656
    v_mov_b32 v4, v5
    v_add_u32 v2, 65536, v5
    s_waitcnt lgkmcnt(2)
    v_mfma_f32_32x32x16_bf16 v[24:39], v[112:115], v[8:11], v[24:39]
    ds_read_b64_tr_b16 v[8:9], v3 offset:8192
    ds_read_b64_tr_b16 v[10:11], v3 offset:8704
    s_waitcnt lgkmcnt(2)
    v_mfma_f32_32x32x16_bf16 v[24:39], v[116:119], v[12:15], v[24:39]
    ds_read_b64_tr_b16 v[12:13], v3 offset:10240
    ds_read_b64_tr_b16 v[14:15], v3 offset:10752
    s_waitcnt lgkmcnt(2)
    v_mfma_f32_32x32x16_bf16 v[24:39], v[120:123], v[8:11], v[24:39]
    ds_read_b64_tr_b16 v[8:9], v3 offset:12288
    ds_read_b64_tr_b16 v[10:11], v3 offset:12800
    s_waitcnt lgkmcnt(2)
    v_mfma_f32_32x32x16_bf16 v[24:39], v[124:127], v[12:15], v[24:39]
    ds_read_b64_tr_b16 v[12:13], v3 offset:14336
    ds_read_b64_tr_b16 v[14:15], v3 offset:14848
    s_waitcnt lgkmcnt(2)
    v_mfma_f32_32x32x16_bf16 v[24:39], v[128:131], v[8:11], v[24:39]
    s_waitcnt lgkmcnt(0)
    v_mfma_f32_32x32x16_bf16 v[24:39], v[132:135], v[12:15], v[24:39]
    s_waitcnt vmcnt(0)
    s_barrier
    ds_read_b64_tr_b16 v[8:9], v3 offset:16384
    ds_read_b64_tr_b16 v[10:11], v3 offset:16896
    ds_read_b128 v[136:139], v16 offset:0
    ds_read_b128 v[140:143], v17 offset:0
    ds_read_b64_tr_b16 v[12:13], v3 offset:18432
    ds_read_b64_tr_b16 v[14:15], v3 offset:18944
    ds_read_b128 v[144:147], v18 offset:0
    ds_read_b128 v[148:151], v19 offset:0
    ds_read_b128 v[152:155], v16 offset:16384
    ds_read_b128 v[156:159], v17 offset:16384
    ds_read_b128 v[160:163], v18 offset:16384
    ds_read_b128 v[164:167], v19 offset:16384
    s_waitcnt lgkmcnt(9)
    v_mfma_f32_32x32x16_bf16 v[24:39], v[136:139], v[8:11], v[24:39]
    ds_read_b64_tr_b16 v[8:9], v3 offset:20480
    ds_read_b64_tr_b16 v[10:11], v3 offset:20992
    s_waitcnt lgkmcnt(8)
    v_mfma_f32_32x32x16_bf16 v[24:39], v[140:143], v[12:15], v[24:39]
    ds_read_b64_tr_b16 v[12:13], v3 offset:22528
    ds_read_b64_tr_b16 v[14:15], v3 offset:23040
    s_waitcnt lgkmcnt(2)
    v_mfma_f32_32x32x16_bf16 v[24:39], v[144:147], v[8:11], v[24:39]
    ds_read_b64_tr_b16 v[8:9], v3 offset:24576
    ds_read_b64_tr_b16 v[10:11], v3 offset:25088
    s_waitcnt lgkmcnt(2)
    v_mfma_f32_32x32x16_bf16 v[24:39], v[148:151], v[12:15], v[24:39]
    ds_read_b64_tr_b16 v[12:13], v3 offset:26624
    ds_read_b64_tr_b16 v[14:15], v3 offset:27136
    s_barrier
    v_and_b32 v7, 0x100, v1
    v_and_b32 v6, 0x2f0, v1
    v_lshl_add_u32 v6, v7, 8, v6
    s_waitcnt lgkmcnt(2)
    v_mfma_f32_32x32x16_bf16 v[24:39], v[152:155], v[8:11], v[24:39]
    ds_read_b64_tr_b16 v[8:9], v3 offset:28672
    ds_read_b64_tr_b16 v[10:11], v3 offset:29184
    s_waitcnt lgkmcnt(2)
    v_mfma_f32_32x32x16_bf16 v[24:39], v[156:159], v[12:15], v[24:39]
    ds_read_b64_tr_b16 v[12:13], v3 offset:30720
    ds_read_b64_tr_b16 v[14:15], v3 offset:31232
    ds_read_b64_tr_b16 v[16:17], v2 offset:4096
    ds_read_b64_tr_b16 v[18:19], v2 offset:4608
    s_waitcnt lgkmcnt(4)
    v_mfma_f32_32x32x16_bf16 v[24:39], v[160:163], v[8:11], v[24:39]
    ds_read_b64_tr_b16 v[8:9], v2 offset:0
    ds_read_b64_tr_b16 v[10:11], v2 offset:512
    v_add_u32 v3, 98304, v4
    s_waitcnt lgkmcnt(4)
    v_mfma_f32_32x32x16_bf16 v[24:39], v[164:167], v[12:15], v[24:39]
    ds_read_b64_tr_b16 v[12:13], v2 offset:2048
    ds_read_b64_tr_b16 v[14:15], v2 offset:2560
    s_add_u32 s48, s41, 0x10000
    s_nop 8
    v_cvt_pk_bf16_f32 v24, v24, v25
    v_cvt_pk_bf16_f32 v25, v26, v27
    v_cvt_pk_bf16_f32 v26, v28, v29
    v_cvt_pk_bf16_f32 v27, v30, v31
    buffer_store_dwordx4 v[24:27], v6, s[16:19], s41 offen sc1
    v_cvt_pk_bf16_f32 v28, v32, v33
    v_cvt_pk_bf16_f32 v29, v34, v35
    v_cvt_pk_bf16_f32 v30, v36, v37
    v_cvt_pk_bf16_f32 v31, v38, v39
    buffer_store_dwordx4 v[28:31], v6, s[16:19], s41 offen offset:256 sc1
    v_mov_b32 v6, s56
    v_mov_b32 v7, s57
    s_waitcnt lgkmcnt(0)
KF_TL:
    ds_read_b64_tr_b16 v[20:21], v2 offset:6144
    ds_read_b64_tr_b16 v[22:23], v2 offset:6656
    s_waitcnt lgkmcnt(6)
    v_mfma_f32_32x32x16_bf16 v[24:39], v[8:11], v[40:43], 0
    ds_read_b64_tr_b16 v[8:9], v2 offset:8192
    ds_read_b64_tr_b16 v[10:11], v2 offset:8704
    s_waitcnt lgkmcnt(6)
    v_mfma_f32_32x32x16_bf16 v[24:39], v[12:15], v[44:47], v[24:39]
    ds_read_b64_tr_b16 v[12:13], v2 offset:10240
    ds_read_b64_tr_b16 v[14:15], v2 offset:10752
    s_waitcnt lgkmcnt(6)
    v_mfma_f32_32x32x16_bf16 v[24:39], v[16:19], v[48:51], v[24:39]
    ds_read_b64_tr_b16 v[16:17], v2 offset:12288
    ds_read_b64_tr_b16 v[18:19], v2 offset:12800
    s_waitcnt lgkmcnt(6)
    v_mfma_f32_32x32x16_bf16 v[24:39], v[20:23], v[52:55], v[24:39]
    ds_read_b64_tr_b16 v[20:21], v2 offset:14336
    ds_read_b64_tr_b16 v[22:23], v2 offset:14848
    s_waitcnt lgkmcnt(6)
    v_mfma_f32_32x32x16_bf16 v[24:39], v[8:11], v[56:59], v[24:39]
    s_barrier
    ds_read_b64_tr_b16 v[8:9], v3 offset:0
    ds_read_b64_tr_b16 v[10:11], v3 offset:512
    s_waitcnt lgkmcnt(6)
    v_mfma_f32_32x32x16_bf16 v[24:39], v[12:15], v[60:63], v[24:39]
    ds_read_b64_tr_b16 v[12:13], v3 offset:2048
    ds_read_b64_tr_b16 v[14:15], v3 offset:2560
    s_waitcnt lgkmcnt(6)
    v_mfma_f32_32x32x16_bf16 v[24:39], v[16:19], v[64:67], v[24:39]
    s_and_b32 s27, s24, 15
    s_lshl_b32 s27, s27, 14
    s_lshr_b64 s[24:25], s[24:25], 4
    v_add_u32 v2, s27, v4
    ds_read_b64_tr_b16 v[16:17], v3 offset:4096
    ds_read_b64_tr_b16 v[18:19], v3 offset:4608
    s_waitcnt lgkmcnt(6)
    v_mfma_f32_32x32x16_bf16 v[24:39], v[20:23], v[68:71], v[24:39]
    ds_read_b64_tr_b16 v[20:21], v3 offset:6144
    ds_read_b64_tr_b16 v[22:23], v3 offset:6656
    s_waitcnt lgkmcnt(6)
    v_mfma_f32_32x32x16_bf16 v[24:39], v[8:11], v[72:75], v[24:39]
    ds_read_b64_tr_b16 v[8:9], v3 offset:8192
    ds_read_b64_tr_b16 v[10:11], v3 offset:8704
    s_waitcnt lgkmcnt(6)
    v_mfma_f32_32x32x16_bf16 v[24:39], v[12:15], v[76:79], v[24:39]
    ds_read_b64_tr_b16 v[12:13], v3 offset:10240
    ds_read_b64_tr_b16 v[14:15], v3 offset:10752
    s_waitcnt lgkmcnt(6)
    v_mfma_f32_32x32x16_bf16 v[24:39], v[16:19], v[80:83], v[24:39]
    ds_read_b64_tr_b16 v[16:17], v3 offset:12288
    ds_read_b64_tr_b16 v[18:19], v3 offset:12800
    s_waitcnt lgkmcnt(6)
    v_mfma_f32_32x32x16_bf16 v[24:39], v[20:23], v[84:87], v[24:39]
    ds_read_b64_tr_b16 v[20:21], v3 offset:14336
    ds_read_b64_tr_b16 v[22:23], v3 offset:14848
    s_waitcnt lgkmcnt(6)
    v_mfma_f32_32x32x16_bf16 v[24:39], v[8:11], v[88:91], v[24:39]
    s_barrier
    ds_read_b64_tr_b16 v[8:9], v2 offset:0
    ds_read_b64_tr_b16 v[10:11], v2 offset:512
    s_waitcnt lgkmcnt(6)
    v_mfma_f32_32x32x16_bf16 v[24:39], v[12:15], v[92:95], v[24:39]
    ds_read_b64_tr_b16 v[12:13], v2 offset:2048
    ds_read_b64_tr_b16 v[14:15], v2 offset:2560
    s_waitcnt lgkmcnt(6)
    v_mfma_f32_32x32x16_bf16 v[24:39], v[16:19], v[96:99], v[24:39]
    s_and_b32 s27, s24, 15
    s_lshl_b32 s27, s27, 14
    s_lshr_b64 s[24:25], s[24:25], 4
    v_add_u32 v3, s27, v4
    ds_read_b64_tr_b16 v[16:17], v2 offset:4096
    ds_read_b64_tr_b16 v[18:19], v2 offset:4608
    s_waitcnt lgkmcnt(6)
    v_mfma_f32_32x32x16_bf16 v[24:39], v[20:23], v[100:103], v[24:39]
    ds_read_b64_tr_b16 v[20:21], v2 offset:6144
    ds_read_b64_tr_b16 v[22:23], v2 offset:6656
    s_waitcnt lgkmcnt(6)
    v_mfma_f32_32x32x16_bf16 v[24:39], v[8:11], v[104:107], v[24:39]
    s_cmp_gt_u32 s46, 2
    s_cbranch_scc1 KF_NF
    s_waitcnt vmcnt(0)
    s_mov_b64 exec, 1
    buffer_store_dwordx2 v[6:7], v1, s[16:19], s42 offen sc1
    s_mov_b64 exec, -1
    s_mov_b32 s42, s30
KF_NF:
    ds_read_b64_tr_b16 v[8:9], v2 offset:8192
    ds_read_b64_tr_b16 v[10:11], v2 offset:8704
    s_waitcnt lgkmcnt(6)
    v_mfma_f32_32x32x16_bf16 v[24:39], v[12:15], v[108:111], v[24:39]
    ds_read_b64_tr_b16 v[12:13], v2 offset:10240
    ds_read_b64_tr_b16 v[14:15], v2 offset:10752
    s_waitcnt lgkmcnt(6)
    v_mfma_f32_32x32x16_bf16 v[24:39], v[16:19], v[112:115], v[24:39]
    s_and_b32 s27, s26, 64
    s_lshr_b32 s26, s26, 8
    v_xor_b32 v4, s27, v5
    ds_read_b64_tr_b16 v[16:17], v2 offset:12288
    ds_read_b64_tr_b16 v[18:19], v2 offset:12800
    s_waitcnt lgkmcnt(6)
    v_mfma_f32_32x32x16_bf16 v[24:39], v[20:23], v[116:119], v[24:39]
    ds_read_b64_tr_b16 v[20:21], v2 offset:14336
    ds_read_b64_tr_b16 v[22:23], v2 offset:14848
    s_waitcnt lgkmcnt(6)
    v_mfma_f32_32x32x16_bf16 v[24:39], v[8:11], v[120:123], v[24:39]
    s_barrier
    ds_read_b64_tr_b16 v[8:9], v3 offset:0
    ds_read_b64_tr_b16 v[10:11], v3 offset:512
    s_waitcnt lgkmcnt(6)
    v_mfma_f32_32x32x16_bf16 v[24:39], v[12:15], v[124:127], v[24:39]
    ds_read_b64_tr_b16 v[12:13], v3 offset:2048
    ds_read_b64_tr_b16 v[14:15], v3 offset:2560
    s_waitcnt lgkmcnt(6)
    v_mfma_f32_32x32x16_bf16 v[24:39], v[16:19], v[128:131], v[24:39]
    s_and_b32 s27, s24, 15
    s_lshl_b32 s27, s27, 14
    s_lshr_b64 s[24:25], s[24:25], 4
    v_add_u32 v2, s27, v4
    ds_read_b64_tr_b16 v[16:17], v3 offset:4096
    ds_read_b64_tr_b16 v[18:19], v3 offset:4608
    s_waitcnt lgkmcnt(6)
    v_mfma_f32_32x32x16_bf16 v[24:39], v[20:23], v[132:135], v[24:39]
    ds_read_b64_tr_b16 v[20:21], v3 offset:6144
    ds_read_b64_tr_b16 v[22:23], v3 offset:6656
    s_waitcnt lgkmcnt(6)
    v_mfma_f32_32x32x16_bf16 v[24:39], v[8:11], v[136:139], v[24:39]
    ds_read_b64_tr_b16 v[8:9], v3 offset:8192
    ds_read_b64_tr_b16 v[10:11], v3 offset:8704
    s_waitcnt lgkmcnt(6)
    v_mfma_f32_32x32x16_bf16 v[24:39], v[12:15], v[140:143], v[24:39]
    ds_read_b64_tr_b16 v[12:13], v3 offset:10240
    ds_read_b64_tr_b16 v[14:15], v3 offset:10752
    s_waitcnt lgkmcnt(6)
    v_mfma_f32_32x32x16_bf16 v[24:39], v[16:19], v[144:147], v[24:39]
    ds_read_b64_tr_b16 v[16:17], v3 offset:12288
    ds_read_b64_tr_b16 v[18:19], v3 offset:12800
    s_waitcnt lgkmcnt(6)
    v_mfma_f32_32x32x16_bf16 v[24:39], v[20:23], v[148:151], v[24:39]
    ds_read_b64_tr_b16 v[20:21], v3 offset:14336
    ds_read_b64_tr_b16 v[22:23], v3 offset:14848
    s_waitcnt lgkmcnt(6)
    v_mfma_f32_32x32x16_bf16 v[24:39], v[8:11], v[152:155], v[24:39]
    s_cmp_gt_u32 s46, 3
    s_cbranch_scc1 KF_NB
    s_barrier
KF_NB:
    ds_read_b64_tr_b16 v[8:9], v2 offset:0
    ds_read_b64_tr_b16 v[10:11], v2 offset:512
    s_waitcnt lgkmcnt(6)
    v_mfma_f32_32x32x16_bf16 v[24:39], v[12:15], v[156:159], v[24:39]
    ds_read_b64_tr_b16 v[12:13], v2 offset:2048
    ds_read_b64_tr_b16 v[14:15], v2 offset:2560
    s_waitcnt lgkmcnt(6)
    v_mfma_f32_32x32x16_bf16 v[24:39], v[16:19], v[160:163], v[24:39]
    s_and_b32 s27, s24, 15
    s_lshl_b32 s27, s27, 14
    s_lshr_b64 s[24:25], s[24:25], 4
    v_add_u32 v3, s27, v4
    ds_read_b64_tr_b16 v[16:17], v2 offset:4096
    ds_read_b64_tr_b16 v[18:19], v2 offset:4608
    s_waitcnt lgkmcnt(6)
    v_mfma_f32_32x32x16_bf16 v[24:39], v[20:23], v[164:167], v[24:39]
    s_cmp_eq_u32 s46, 0
    s_cbranch_scc1 KF_QEPI
    s_nop 9
    v_pk_mul_f32 v[24:25], v[24:25], v[32:33]
    v_pk_mul_f32 v[26:27], v[26:27], v[34:35]
    v_pk_mul_f32 v[28:29], v[28:29], v[36:37]
    v_pk_mul_f32 v[30:31], v[30:31], v[38:39]
    v_cvt_pk_bf16_f32 v24, v24, v25
    v_cvt_pk_bf16_f32 v25, v26, v27
    v_cvt_pk_bf16_f32 v26, v28, v29
    v_cvt_pk_bf16_f32 v27, v30, v31
    buffer_store_dwordx4 v[24:27], v1, s[16:19], s43 offen sc1
    s_mov_b32 s43, s49
    s_add_u32 s49, s49, 2048
KF_TE:
KF_TE2:
    s_add_u32 s46, s46, 2
    s_cmp_lt_u32 s46, 6
    s_cbranch_scc1 KF_TL
    ds_read_b64_tr_b16 v[20:21], v2 offset:6144
    ds_read_b64_tr_b16 v[22:23], v2 offset:6656
    s_waitcnt lgkmcnt(6)
    v_mfma_f32_32x32x16_bf16 v[24:39], v[8:11], v[40:43], 0
    ds_read_b64_tr_b16 v[8:9], v2 offset:8192
    ds_read_b64_tr_b16 v[10:11], v2 offset:8704
    s_waitcnt lgkmcnt(6)
    v_mfma_f32_32x32x16_bf16 v[24:39], v[12:15], v[44:47], v[24:39]
    v_lshlrev_b32 v4, 2, v0
    v_mov_b32 v5, 0
    ds_write_b32 v4, v5 offset:0
    v_and_b32 v40, 0x3ff, v4
    s_mov_b32 s44, 0x0000ffff
    s_mov_b32 s45, 0x0000ffff
    ds_read_b64_tr_b16 v[12:13], v2 offset:10240
    ds_read_b64_tr_b16 v[14:15], v2 offset:10752
    s_waitcnt lgkmcnt(6)
    v_mfma_f32_32x32x16_bf16 v[24:39], v[16:19], v[48:51], v[24:39]
    v_bfe_u32 v5, v1, 4, 2
    s_lshl_b32 s48, s37, 2
    v_add_u32 v5, s48, v5
    v_mul_u32_u24 v5, 0x104, v5
    s_lshl_b32 s61, s58, 16
    s_add_u32 s61, s61, s52
    s_mov_b32 s24, s52
    s_add_u32 s25, s52, 0x1000
    s_and_b32 s25, s25, 0xffff
    s_add_u32 s52, s52, 0x2000
    s_and_b32 s52, s52, 0xffff
    ds_read_b64_tr_b16 v[16:17], v2 offset:12288
    ds_read_b64_tr_b16 v[18:19], v2 offset:12800
    s_waitcnt lgkmcnt(6)
    v_mfma_f32_32x32x16_bf16 v[24:39], v[20:23], v[52:55], v[24:39]
    ds_read_b64_tr_b16 v[20:21], v2 offset:14336
    ds_read_b64_tr_b16 v[22:23], v2 offset:14848
    s_waitcnt lgkmcnt(6)
    v_mfma_f32_32x32x16_bf16 v[24:39], v[8:11], v[56:59], v[24:39]
    ds_read_b32 v41, v40 offset:3072
    ds_read_b64_tr_b16 v[8:9], v3 offset:0
    ds_read_b64_tr_b16 v[10:11], v3 offset:512
    s_waitcnt lgkmcnt(7)
    v_mfma_f32_32x32x16_bf16 v[24:39], v[12:15], v[60:63], v[24:39]
    ds_read_b64_tr_b16 v[12:13], v3 offset:2048
    ds_read_b64_tr_b16 v[14:15], v3 offset:2560
    s_waitcnt lgkmcnt(7)
    v_mfma_f32_32x32x16_bf16 v[24:39], v[16:19], v[64:67], v[24:39]
    v_add_u32 v2, 65536, v2
    s_waitcnt lgkmcnt(4)
    v_cmp_ne_u32 vcc, 0, v41
    s_mov_b64 s[62:63], vcc
    s_cmp_lg_u64 s[62:63], 0
    s_cbranch_scc1 KF_NL0
    s_add_u32 s48, s36, 0
    s_and_b32 s48, s48, 3
    s_lshl_b32 s48, s48, 10
    s_add_u32 s48, s48, s61
    buffer_load_dwordx4 v[40:43], v1, s[16:19], s48 offen sc1
KF_NL0:
    ds_read_b64_tr_b16 v[16:17], v3 offset:4096
    ds_read_b64_tr_b16 v[18:19], v3 offset:4608
    v_mfma_f32_32x32x16_bf16 v[24:39], v[20:23], v[68:71], v[24:39]
    v_and_b32 v68, 432, v1
    v_cmp_eq_u32 vcc, 256, v68
    v_mov_b32 v68, 0x3f803f80
    s_nop 0
    v_cndmask_b32 v68, 0, v68, vcc
    v_mov_b32 v52, v68
    v_mov_b32 v69, v52
    v_mov_b32 v70, v52
    v_mov_b32 v71, v52
    ds_read_b64_tr_b16 v[20:21], v3 offset:6144
    ds_read_b64_tr_b16 v[22:23], v3 offset:6656
    s_waitcnt lgkmcnt(6)
    v_mfma_f32_32x32x16_bf16 v[24:39], v[8:11], v[72:75], v[24:39]
    v_mov_b32 v72, v52
    v_mov_b32 v73, v52
    v_mov_b32 v74, v52
    v_mov_b32 v75, v52
    s_cmp_lg_u64 s[62:63], 0
    s_cbranch_scc1 KF_NL1
    s_add_u32 s53, s50, s24
    buffer_load_dwordx4 v[56:59], v1, s[16:19], s53 offen sc1
KF_NL1:
    ds_read_b64_tr_b16 v[8:9], v3 offset:8192
    ds_read_b64_tr_b16 v[10:11], v3 offset:8704
    s_waitcnt lgkmcnt(6)
    v_mfma_f32_32x32x16_bf16 v[24:39], v[12:15], v[76:79], v[24:39]
    v_mov_b32 v76, v52
    v_mov_b32 v77, v52
    v_mov_b32 v78, v52
    v_mov_b32 v79, v52
    ds_read_b64_tr_b16 v[12:13], v3 offset:10240
    ds_read_b64_tr_b16 v[14:15], v3 offset:10752
    s_waitcnt lgkmcnt(6)
    v_mfma_f32_32x32x16_bf16 v[24:39], v[16:19], v[80:83], v[24:39]
    v_mov_b32 v80, v52
    v_mov_b32 v81, v52
    v_mov_b32 v82, v52
    v_mov_b32 v83, v52
    s_cmp_lg_u64 s[62:63], 0
    s_cbranch_scc1 KF_NL2
    s_add_u32 s48, s51, s24
    s_mov_b64 exec, s[44:45]
    buffer_load_dwordx4 v[68:71], v1, s[16:19], s48 offen offset:0 sc1
    s_mov_b64 exec, -1
KF_NL2:
    ds_read_b64_tr_b16 v[16:17], v3 offset:12288
    ds_read_b64_tr_b16 v[18:19], v3 offset:12800
    s_waitcnt lgkmcnt(6)
    v_mfma_f32_32x32x16_bf16 v[24:39], v[20:23], v[84:87], v[24:39]
    v_mov_b32 v84, v52
    v_mov_b32 v85, v52
    v_mov_b32 v86, v52
    v_mov_b32 v87, v52
    s_cmp_lg_u64 s[62:63], 0
    s_cbranch_scc1 KF_NL3
    s_add_u32 s48, s51, s24
    s_mov_b64 exec, s[44:45]
    buffer_load_dwordx4 v[72:75], v1, s[16:19], s48 offen offset:256 sc1
    s_mov_b64 exec, -1
KF_NL3:
    ds_read_b64_tr_b16 v[20:21], v3 offset:14336
    ds_read_b64_tr_b16 v[22:23], v3 offset:14848
    s_waitcnt lgkmcnt(6)
    v_mfma_f32_32x32x16_bf16 v[24:39], v[8:11], v[88:91], v[24:39]
    v_mov_b32 v88, v52
    v_mov_b32 v89, v52
    v_mov_b32 v90, v52
    v_mov_b32 v91, v52
    ds_read_b64_tr_b16 v[8:9], v2 offset:0
    ds_read_b64_tr_b16 v[10:11], v2 offset:512
    s_waitcnt lgkmcnt(6)
    v_mfma_f32_32x32x16_bf16 v[24:39], v[12:15], v[92:95], v[24:39]
    s_cmp_lg_u64 s[62:63], 0
    s_cbranch_scc1 KF_NL4
    s_add_u32 s48, s36, 1
    s_and_b32 s48, s48, 3
    s_lshl_b32 s48, s48, 10
    s_add_u32 s48, s48, s61
    buffer_load_dwordx4 v[44:47], v1, s[16:19], s48 offen sc1
KF_NL4:
    ds_read_b64_tr_b16 v[12:13], v2 offset:2048
    ds_read_b64_tr_b16 v[14:15], v2 offset:2560
    s_waitcnt lgkmcnt(6)
    v_mfma_f32_32x32x16_bf16 v[24:39], v[16:19], v[96:99], v[24:39]
    v_add_u32 v3, 65536, v3
    v_mov_b32 v92, 0
    v_mov_b32 v93, 0
    v_mov_b32 v94, 0
    v_mov_b32 v95, 0
    ds_read_b64_tr_b16 v[16:17], v2 offset:4096
    ds_read_b64_tr_b16 v[18:19], v2 offset:4608
    s_waitcnt lgkmcnt(6)
    v_mfma_f32_32x32x16_bf16 v[24:39], v[20:23], v[100:103], v[24:39]
    s_cmp_lg_u64 s[62:63], 0
    s_cbranch_scc1 KF_NL5
    s_add_u32 s48, s36, 2
    s_and_b32 s48, s48, 3
    s_lshl_b32 s48, s48, 10
    s_add_u32 s48, s48, s61
    buffer_load_dwordx4 v[48:51], v1, s[16:19], s48 offen sc1
KF_NL5:
    v_mov_b32 v96, 0
    v_mov_b32 v97, 0
    v_mov_b32 v98, 0
    v_mov_b32 v99, 0
    ds_read_b64_tr_b16 v[20:21], v2 offset:6144
    ds_read_b64_tr_b16 v[22:23], v2 offset:6656
    s_waitcnt lgkmcnt(6)
    v_mfma_f32_32x32x16_bf16 v[24:39], v[8:11], v[104:107], v[24:39]
    v_mov_b32 v100, 0
    v_mov_b32 v101, 0
    v_mov_b32 v102, 0
    v_mov_b32 v103, 0
    ds_read_b64_tr_b16 v[8:9], v2 offset:8192
    ds_read_b64_tr_b16 v[10:11], v2 offset:8704
    s_waitcnt lgkmcnt(6)
    v_mfma_f32_32x32x16_bf16 v[24:39], v[12:15], v[108:111], v[24:39]
    s_cmp_lg_u64 s[62:63], 0
    s_cbranch_scc1 KF_NL6
    s_add_u32 s48, s36, 3
    s_and_b32 s48, s48, 3
    s_lshl_b32 s48, s48, 10
    s_add_u32 s48, s48, s61
    buffer_load_dwordx4 v[52:55], v1, s[16:19], s48 offen sc1
KF_NL6:
    v_mov_b32 v104, 0
    v_mov_b32 v105, 0
    v_mov_b32 v106, 0
    v_mov_b32 v107, 0
    ds_read_b64_tr_b16 v[12:13], v2 offset:10240
    ds_read_b64_tr_b16 v[14:15], v2 offset:10752
    s_waitcnt lgkmcnt(6)
    v_mfma_f32_32x32x16_bf16 v[24:39], v[16:19], v[112:115], v[24:39]
    v_mov_b32 v108, 0
    v_mov_b32 v109, 0
    v_mov_b32 v110, 0
    v_mov_b32 v111, 0
    ds_read_b64_tr_b16 v[16:17], v2 offset:12288
    ds_read_b64_tr_b16 v[18:19], v2 offset:12800
    s_waitcnt lgkmcnt(6)
    v_mfma_f32_32x32x16_bf16 v[24:39], v[20:23], v[116:119], v[24:39]
    s_cmp_lg_u64 s[62:63], 0
    s_cbranch_scc1 KF_NL7
    s_add_u32 s53, s50, s25
    buffer_load_dwordx4 v[60:63], v1, s[16:19], s53 offen sc1
KF_NL7:
    v_mov_b32 v112, 0
    v_mov_b32 v113, 0
    v_mov_b32 v114, 0
    v_mov_b32 v115, 0
    ds_read_b64_tr_b16 v[20:21], v2 offset:14336
    ds_read_b64_tr_b16 v[22:23], v2 offset:14848
    s_waitcnt lgkmcnt(6)
    v_mfma_f32_32x32x16_bf16 v[24:39], v[8:11], v[120:123], v[24:39]
    v_mov_b32 v116, 0
    v_mov_b32 v117, 0
    v_mov_b32 v118, 0
    v_mov_b32 v119, 0
    ds_read_b64_tr_b16 v[8:9], v3 offset:0
    ds_read_b64_tr_b16 v[10:11], v3 offset:512
    s_waitcnt lgkmcnt(6)
    v_mfma_f32_32x32x16_bf16 v[24:39], v[12:15], v[124:127], v[24:39]
    s_cmp_lg_u64 s[62:63], 0
    s_cbranch_scc1 KF_NL8
    s_add_u32 s48, s51, s25
    s_mov_b64 exec, s[44:45]
    buffer_load_dwordx4 v[76:79], v1, s[16:19], s48 offen offset:0 sc1
    s_mov_b64 exec, -1
KF_NL8:
    v_mov_b32 v120, 0
    v_mov_b32 v121, 0
    v_mov_b32 v122, 0
    v_mov_b32 v123, 0
    ds_read_b64_tr_b16 v[12:13], v3 offset:2048
    ds_read_b64_tr_b16 v[14:15], v3 offset:2560
    s_waitcnt lgkmcnt(6)
    v_mfma_f32_32x32x16_bf16 v[24:39], v[16:19], v[128:131], v[24:39]
    s_cmp_lg_u64 s[62:63], 0
    s_cbranch_scc1 KF_NL9
    s_add_u32 s48, s51, s25
    s_mov_b64 exec, s[44:45]
    buffer_load_dwordx4 v[80:83], v1, s[16:19], s48 offen offset:256 sc1
    s_mov_b64 exec, -1
KF_NL9:
    v_mov_b32 v124, 0
    v_mov_b32 v125, 0
    v_mov_b32 v126, 0
    v_mov_b32 v127, 0
    ds_read_b64_tr_b16 v[16:17], v3 offset:4096
    ds_read_b64_tr_b16 v[18:19], v3 offset:4608
    s_waitcnt lgkmcnt(6)
    v_mfma_f32_32x32x16_bf16 v[24:39], v[20:23], v[132:135], v[24:39]
    v_mov_b32 v128, 0
    v_mov_b32 v129, 0
    v_mov_b32 v130, 0
    v_mov_b32 v131, 0
    ds_read_b64_tr_b16 v[20:21], v3 offset:6144
    ds_read_b64_tr_b16 v[22:23], v3 offset:6656
    s_waitcnt lgkmcnt(6)
    v_mfma_f32_32x32x16_bf16 v[24:39], v[8:11], v[136:139], v[24:39]
    s_barrier
    s_cmp_lg_u64 s[62:63], 0
    s_cbranch_scc1 KF_NL10
    s_add_u32 s53, s50, s52
    buffer_load_dwordx4 v[64:67], v1, s[16:19], s53 offen sc1
KF_NL10:
    v_mov_b32 v132, 0
    v_mov_b32 v133, 0
    v_mov_b32 v134, 0
    v_mov_b32 v135, 0
    ds_read_b64_tr_b16 v[8:9], v3 offset:8192
    ds_read_b64_tr_b16 v[10:11], v3 offset:8704
    s_waitcnt lgkmcnt(6)
    v_mfma_f32_32x32x16_bf16 v[24:39], v[12:15], v[140:143], v[24:39]
    v_mov_b32 v136, 0
    v_mov_b32 v137, 0
    v_mov_b32 v138, 0
    v_mov_b32 v139, 0
    ds_read_b64_tr_b16 v[12:13], v3 offset:10240
    ds_read_b64_tr_b16 v[14:15], v3 offset:10752
    s_waitcnt lgkmcnt(6)
    v_mfma_f32_32x32x16_bf16 v[24:39], v[16:19], v[144:147], v[24:39]
    v_mov_b32 v140, 0
    v_mov_b32 v141, 0
    v_mov_b32 v142, 0
    v_mov_b32 v143, 0
    ds_read_b64_tr_b16 v[16:17], v3 offset:12288
    ds_read_b64_tr_b16 v[18:19], v3 offset:12800
    s_waitcnt lgkmcnt(6)
    v_mfma_f32_32x32x16_bf16 v[24:39], v[20:23], v[148:151], v[24:39]
    v_mov_b32 v144, 0
    v_mov_b32 v145, 0
    v_mov_b32 v146, 0
    v_mov_b32 v147, 0
    ds_read_b64_tr_b16 v[20:21], v3 offset:14336
    ds_read_b64_tr_b16 v[22:23], v3 offset:14848
    s_waitcnt lgkmcnt(6)
    v_mfma_f32_32x32x16_bf16 v[24:39], v[8:11], v[152:155], v[24:39]
    v_mov_b32 v148, 0
    v_mov_b32 v149, 0
    v_mov_b32 v150, 0
    v_mov_b32 v151, 0
    s_mov_b32 s46, 0
    s_cmp_eq_u32 s37, 0
    s_cselect_b32 s47, 0, 503
    s_cbranch_scc1 KF_NP
    s_setprio 1
KF_NP:
    s_waitcnt lgkmcnt(4)
    v_mfma_f32_32x32x16_bf16 v[24:39], v[12:15], v[156:159], v[24:39]
    v_mov_b32 v152, 0
    v_mov_b32 v153, 0
    v_mov_b32 v154, 0
    v_mov_b32 v155, 0
    s_waitcnt lgkmcnt(2)
    v_mfma_f32_32x32x16_bf16 v[24:39], v[16:19], v[160:163], v[24:39]
    v_mov_b32 v156, 0
    v_mov_b32 v157, 0
    v_mov_b32 v158, 0
    v_mov_b32 v159, 0
    s_waitcnt lgkmcnt(0)
    v_mfma_f32_32x32x16_bf16 v[24:39], v[20:23], v[164:167], v[24:39]
    s_cmp_lg_u64 s[62:63], 0
    s_cbranch_scc1 KF_SLOW
KF_GO:
    s_waitcnt vmcnt(9)
    v_mfma_f32_32x32x16_bf16 v[8:23], v[56:59], v[40:43], 0
KF_GO2:
    v_mov_b32 v160, 0
    v_mov_b32 v161, 0
    v_mov_b32 v162, 0
    v_mov_b32 v163, 0
    s_nop 3
    v_pk_mul_f32 v[24:25], v[24:25], v[32:33]
    v_pk_mul_f32 v[26:27], v[26:27], v[34:35]
    v_pk_mul_f32 v[28:29], v[28:29], v[36:37]
    v_pk_mul_f32 v[30:31], v[30:31], v[38:39]
    v_cvt_pk_bf16_f32 v164, v24, v25
    v_cvt_pk_bf16_f32 v165, v26, v27
    v_cvt_pk_bf16_f32 v166, v28, v29
    v_cvt_pk_bf16_f32 v167, v30, v31
    buffer_store_dwordx4 v[164:167], v1, s[16:19], s43 offen sc1
    s_waitcnt vmcnt(5)
    s_cmp_lg_u64 s[62:63], 0
    s_cbranch_scc0 KF_AL_IN
    s_waitcnt vmcnt(0)
    v_mov_b32 v156, -1
    ds_write_b32 v4, v156 offset:0
    s_mov_b64 exec, 1
    buffer_store_dwordx2 v[6:7], v1, s[16:19], s55 offen sc1
    s_branch KF_FIN
KF_AL:
    s_bitcmp1_b32 s47, 0
    s_setprio 0
    s_cbranch_scc0 KF_AL_B0
    s_setprio 1
KF_AL_B0:
    s_lshr_b32 s47, s47, 1
    v_exp_f32 v8, v8
    v_exp_f32 v9, v9
    v_mfma_f32_32x32x16_bf16 v[140:155], v[72:75], v[160:163], v[140:155]
    s_add_u32 s48, s51, s52
    s_mov_b64 exec, s[44:45]
    buffer_load_dwordx4 v[68:71], v1, s[16:19], s48 offen sc1
    buffer_load_dwordx4 v[72:75], v1, s[16:19], s48 offen offset:256 sc1
    s_mov_b64 exec, -1
    s_add_u32 s52, s52, 0x1000
    s_and_b32 s52, s52, 0xffff
    s_add_u32 s53, s50, s52
    v_exp_f32 v10, v10
    v_exp_f32 v11, v11
    v_exp_f32 v12, v12
    v_exp_f32 v13, v13
    v_mfma_f32_32x32x16_bf16 v[24:39], v[60:63], v[44:47], 0
    v_exp_f32 v14, v14
    v_exp_f32 v15, v15
    v_cvt_pk_bf16_f32 v156, v8, v9
    v_cvt_pk_bf16_f32 v157, v10, v11
    v_cvt_pk_bf16_f32 v158, v12, v13
    v_cvt_pk_bf16_f32 v159, v14, v15
    v_exp_f32 v16, v16
    v_exp_f32 v17, v17
    v_mfma_f32_32x32x16_bf16 v[92:107], v[76:79], v[156:159], v[92:107]
    v_exp_f32 v18, v18
    v_exp_f32 v19, v19
    v_exp_f32 v20, v20
    v_exp_f32 v21, v21
    v_exp_f32 v22, v22
    v_exp_f32 v23, v23
    v_cvt_pk_bf16_f32 v160, v16, v17
    v_cvt_pk_bf16_f32 v161, v18, v19
    v_cvt_pk_bf16_f32 v162, v20, v21
    v_cvt_pk_bf16_f32 v163, v22, v23
    v_exp_f32 v24, v24
    v_exp_f32 v25, v25
    v_mfma_f32_32x32x16_bf16 v[92:107], v[80:83], v[160:163], v[92:107]
    v_exp_f32 v26, v26
    v_exp_f32 v27, v27
    v_exp_f32 v28, v28
    v_exp_f32 v29, v29
    v_mfma_f32_32x32x16_bf16 v[8:23], v[60:63], v[48:51], 0
    v_exp_f32 v30, v30
    v_exp_f32 v31, v31
    v_cvt_pk_bf16_f32 v156, v24, v25
    v_cvt_pk_bf16_f32 v157, v26, v27
    v_cvt_pk_bf16_f32 v158, v28, v29
    v_cvt_pk_bf16_f32 v159, v30, v31
    v_exp_f32 v32, v32
    v_exp_f32 v33, v33
    v_mfma_f32_32x32x16_bf16 v[108:123], v[76:79], v[156:159], v[108:123]
    v_exp_f32 v34, v34
    v_exp_f32 v35, v35
    v_exp_f32 v36, v36
    v_exp_f32 v37, v37
    v_exp_f32 v38, v38
    v_exp_f32 v39, v39
    v_cvt_pk_bf16_f32 v160, v32, v33
    v_cvt_pk_bf16_f32 v161, v34, v35
    v_cvt_pk_bf16_f32 v162, v36, v37
    v_cvt_pk_bf16_f32 v163, v38, v39
    v_exp_f32 v8, v8
    v_exp_f32 v9, v9
    v_mfma_f32_32x32x16_bf16 v[108:123], v[80:83], v[160:163], v[108:123]
    v_exp_f32 v10, v10
    v_exp_f32 v11, v11
    v_exp_f32 v12, v12
    v_exp_f32 v13, v13
    v_mfma_f32_32x32x16_bf16 v[24:39], v[60:63], v[52:55], 0
    buffer_load_dwordx4 v[60:63], v1, s[16:19], s53 offen sc1
    v_exp_f32 v14, v14
    v_exp_f32 v15, v15
    v_cvt_pk_bf16_f32 v156, v8, v9
    v_cvt_pk_bf16_f32 v157, v10, v11
    v_cvt_pk_bf16_f32 v158, v12, v13
    v_cvt_pk_bf16_f32 v159, v14, v15
    v_exp_f32 v16, v16
    v_exp_f32 v17, v17
    v_mfma_f32_32x32x16_bf16 v[124:139], v[76:79], v[156:159], v[124:139]
    v_exp_f32 v18, v18
    v_exp_f32 v19, v19
    v_exp_f32 v20, v20
    v_exp_f32 v21, v21
    v_exp_f32 v22, v22
    v_exp_f32 v23, v23
    v_cvt_pk_bf16_f32 v160, v16, v17
    v_cvt_pk_bf16_f32 v161, v18, v19
    v_cvt_pk_bf16_f32 v162, v20, v21
    v_cvt_pk_bf16_f32 v163, v22, v23
    v_exp_f32 v24, v24
    v_exp_f32 v25, v25
    v_mfma_f32_32x32x16_bf16 v[124:139], v[80:83], v[160:163], v[124:139]
    v_exp_f32 v26, v26
    v_exp_f32 v27, v27
    v_exp_f32 v28, v28
    v_exp_f32 v29, v29
    s_waitcnt vmcnt(4)
    v_mfma_f32_32x32x16_bf16 v[8:23], v[64:67], v[40:43], 0
    v_exp_f32 v30, v30
    v_exp_f32 v31, v31
    v_cvt_pk_bf16_f32 v156, v24, v25
    v_cvt_pk_bf16_f32 v157, v26, v27
    v_cvt_pk_bf16_f32 v158, v28, v29
    v_cvt_pk_bf16_f32 v159, v30, v31
    v_exp_f32 v32, v32
    v_exp_f32 v33, v33
    v_mfma_f32_32x32x16_bf16 v[140:155], v[76:79], v[156:159], v[140:155]
    v_exp_f32 v34, v34
    v_exp_f32 v35, v35
    v_exp_f32 v36, v36
    v_exp_f32 v37, v37
    v_exp_f32 v38, v38
    v_exp_f32 v39, v39
    v_cvt_pk_bf16_f32 v160, v32, v33
    v_cvt_pk_bf16_f32 v161, v34, v35
    v_cvt_pk_bf16_f32 v162, v36, v37
    v_cvt_pk_bf16_f32 v163, v38, v39
    s_bitcmp1_b32 s47, 0
    s_setprio 0
    s_cbranch_scc0 KF_AL_B1
    s_setprio 1
KF_AL_B1:
    s_lshr_b32 s47, s47, 1
    v_exp_f32 v8, v8
    v_exp_f32 v9, v9
    v_mfma_f32_32x32x16_bf16 v[140:155], v[80:83], v[160:163], v[140:155]
    s_cmp_lg_u32 s46, 1
    s_cbranch_scc1 KF_NOHF
    s_mov_b64 exec, 1
    buffer_store_dwordx2 v[6:7], v1, s[16:19], s55 offen sc1
    v_mov_b32 v2, 1
    ds_write_b32 v4, v2 offset:128
    s_mov_b64 exec, -1
    s_setprio 0
KF_NOHF:
    s_add_u32 s48, s51, s52
    s_mov_b64 exec, s[44:45]
    buffer_load_dwordx4 v[76:79], v1, s[16:19], s48 offen sc1
    buffer_load_dwordx4 v[80:83], v1, s[16:19], s48 offen offset:256 sc1
    s_mov_b64 exec, -1
    s_add_u32 s52, s52, 0x1000
    s_and_b32 s52, s52, 0xffff
    s_add_u32 s53, s50, s52
    v_exp_f32 v10, v10
    v_exp_f32 v11, v11
    v_exp_f32 v12, v12
    v_exp_f32 v13, v13
    v_mfma_f32_32x32x16_bf16 v[24:39], v[64:67], v[44:47], 0
    v_exp_f32 v14, v14
    v_exp_f32 v15, v15
    v_cvt_pk_bf16_f32 v156, v8, v9
    v_cvt_pk_bf16_f32 v157, v10, v11
    v_cvt_pk_bf16_f32 v158, v12, v13
    v_cvt_pk_bf16_f32 v159, v14, v15
    v_exp_f32 v16, v16
    v_exp_f32 v17, v17
    v_mfma_f32_32x32x16_bf16 v[92:107], v[84:87], v[156:159], v[92:107]
    v_exp_f32 v18, v18
    v_exp_f32 v19, v19
    v_exp_f32 v20, v20
    v_exp_f32 v21, v21
    v_exp_f32 v22, v22
    v_exp_f32 v23, v23
    v_cvt_pk_bf16_f32 v160, v16, v17
    v_cvt_pk_bf16_f32 v161, v18, v19
    v_cvt_pk_bf16_f32 v162, v20, v21
    v_cvt_pk_bf16_f32 v163, v22, v23
    v_exp_f32 v24, v24
    v_exp_f32 v25, v25
    v_mfma_f32_32x32x16_bf16 v[92:107], v[88:91], v[160:163], v[92:107]
    v_exp_f32 v26, v26
    v_exp_f32 v27, v27
    v_exp_f32 v28, v28
    v_exp_f32 v29, v29
    v_mfma_f32_32x32x16_bf16 v[8:23], v[64:67], v[48:51], 0
    v_exp_f32 v30, v30
    v_exp_f32 v31, v31
    v_cvt_pk_bf16_f32 v156, v24, v25
    v_cvt_pk_bf16_f32 v157, v26, v27
    v_cvt_pk_bf16_f32 v158, v28, v29
    v_cvt_pk_bf16_f32 v159, v30, v31
    v_exp_f32 v32, v32
    v_exp_f32 v33, v33
    v_mfma_f32_32x32x16_bf16 v[108:123], v[84:87], v[156:159], v[108:123]
    v_exp_f32 v34, v34
    v_exp_f32 v35, v35
    v_exp_f32 v36, v36
    v_exp_f32 v37, v37
    v_exp_f32 v38, v38
    v_exp_f32 v39, v39
    v_cvt_pk_bf16_f32 v160, v32, v33
    v_cvt_pk_bf16_f32 v161, v34, v35
    v_cvt_pk_bf16_f32 v162, v36, v37
    v_cvt_pk_bf16_f32 v163, v38, v39
    v_exp_f32 v8, v8
    v_exp_f32 v9, v9
    v_mfma_f32_32x32x16_bf16 v[108:123], v[88:91], v[160:163], v[108:123]
    v_exp_f32 v10, v10
    v_exp_f32 v11, v11
    v_exp_f32 v12, v12
    v_exp_f32 v13, v13
    v_mfma_f32_32x32x16_bf16 v[24:39], v[64:67], v[52:55], 0
    buffer_load_dwordx4 v[64:67], v1, s[16:19], s53 offen sc1
    v_exp_f32 v14, v14
    v_exp_f32 v15, v15
    v_cvt_pk_bf16_f32 v156, v8, v9
    v_cvt_pk_bf16_f32 v157, v10, v11
    v_cvt_pk_bf16_f32 v158, v12, v13
    v_cvt_pk_bf16_f32 v159, v14, v15
    v_exp_f32 v16, v16
    v_exp_f32 v17, v17
    v_mfma_f32_32x32x16_bf16 v[124:139], v[84:87], v[156:159], v[124:139]
    v_exp_f32 v18, v18
    v_exp_f32 v19, v19
    v_exp_f32 v20, v20
    v_exp_f32 v21, v21
    v_exp_f32 v22, v22
    v_exp_f32 v23, v23
    v_cvt_pk_bf16_f32 v160, v16, v17
    v_cvt_pk_bf16_f32 v161, v18, v19
    v_cvt_pk_bf16_f32 v162, v20, v21
    v_cvt_pk_bf16_f32 v163, v22, v23
    v_exp_f32 v24, v24
    v_exp_f32 v25, v25
    v_mfma_f32_32x32x16_bf16 v[124:139], v[88:91], v[160:163], v[124:139]
    v_exp_f32 v26, v26
    v_exp_f32 v27, v27
    v_exp_f32 v28, v28
    v_exp_f32 v29, v29
    s_waitcnt vmcnt(4)
    v_mfma_f32_32x32x16_bf16 v[8:23], v[56:59], v[40:43], 0
    v_exp_f32 v30, v30
    v_exp_f32 v31, v31
    v_cvt_pk_bf16_f32 v156, v24, v25
    v_cvt_pk_bf16_f32 v157, v26, v27
    v_cvt_pk_bf16_f32 v158, v28, v29
    v_cvt_pk_bf16_f32 v159, v30, v31
    v_exp_f32 v32, v32
    v_exp_f32 v33, v33
    v_mfma_f32_32x32x16_bf16 v[140:155], v[84:87], v[156:159], v[140:155]
    v_exp_f32 v34, v34
    v_exp_f32 v35, v35
    v_exp_f32 v36, v36
    v_exp_f32 v37, v37
    v_exp_f32 v38, v38
    v_exp_f32 v39, v39
    v_cvt_pk_bf16_f32 v160, v32, v33
    v_cvt_pk_bf16_f32 v161, v34, v35
    v_cvt_pk_bf16_f32 v162, v36, v37
    v_cvt_pk_bf16_f32 v163, v38, v39
KF_AL_IN:
    s_bitcmp1_b32 s47, 0
    s_setprio 0
    s_cbranch_scc0 KF_AL_B2
    s_setprio 1
KF_AL_B2:
    s_lshr_b32 s47, s47, 1
    v_exp_f32 v8, v8
    v_exp_f32 v9, v9
    v_mfma_f32_32x32x16_bf16 v[140:155], v[88:91], v[160:163], v[140:155]
    s_add_u32 s48, s51, s52
    s_mov_b64 exec, s[44:45]
    buffer_load_dwordx4 v[84:87], v1, s[16:19], s48 offen sc1
    buffer_load_dwordx4 v[88:91], v1, s[16:19], s48 offen offset:256 sc1
    s_mov_b64 exec, -1
    s_add_u32 s52, s52, 0x1000
    s_and_b32 s52, s52, 0xffff
    s_add_u32 s53, s50, s52
    v_exp_f32 v10, v10
    v_exp_f32 v11, v11
    v_exp_f32 v12, v12
    v_exp_f32 v13, v13
    v_mfma_f32_32x32x16_bf16 v[24:39], v[56:59], v[44:47], 0
    v_exp_f32 v14, v14
    v_exp_f32 v15, v15
    v_cvt_pk_bf16_f32 v156, v8, v9
    v_cvt_pk_bf16_f32 v157, v10, v11
    v_cvt_pk_bf16_f32 v158, v12, v13
    v_cvt_pk_bf16_f32 v159, v14, v15
    v_exp_f32 v16, v16
    v_exp_f32 v17, v17
    v_mfma_f32_32x32x16_bf16 v[92:107], v[68:71], v[156:159], v[92:107]
    v_exp_f32 v18, v18
    v_exp_f32 v19, v19
    v_exp_f32 v20, v20
    v_exp_f32 v21, v21
    v_exp_f32 v22, v22
    v_exp_f32 v23, v23
    v_cvt_pk_bf16_f32 v160, v16, v17
    v_cvt_pk_bf16_f32 v161, v18, v19
    v_cvt_pk_bf16_f32 v162, v20, v21
    v_cvt_pk_bf16_f32 v163, v22, v23
    v_exp_f32 v24, v24
    v_exp_f32 v25, v25
    v_mfma_f32_32x32x16_bf16 v[92:107], v[72:75], v[160:163], v[92:107]
    v_exp_f32 v26, v26
    v_exp_f32 v27, v27
    v_exp_f32 v28, v28
    v_exp_f32 v29, v29
    v_mfma_f32_32x32x16_bf16 v[8:23], v[56:59], v[48:51], 0
    v_exp_f32 v30, v30
    v_exp_f32 v31, v31
    v_cvt_pk_bf16_f32 v156, v24, v25
    v_cvt_pk_bf16_f32 v157, v26, v27
    v_cvt_pk_bf16_f32 v158, v28, v29
    v_cvt_pk_bf16_f32 v159, v30, v31
    v_exp_f32 v32, v32
    v_exp_f32 v33, v33
    v_mfma_f32_32x32x16_bf16 v[108:123], v[68:71], v[156:159], v[108:123]
    v_exp_f32 v34, v34
    v_exp_f32 v35, v35
    v_exp_f32 v36, v36
    v_exp_f32 v37, v37
    v_exp_f32 v38, v38
    v_exp_f32 v39, v39
    v_cvt_pk_bf16_f32 v160, v32, v33
    v_cvt_pk_bf16_f32 v161, v34, v35
    v_cvt_pk_bf16_f32 v162, v36, v37
    v_cvt_pk_bf16_f32 v163, v38, v39
    v_exp_f32 v8, v8
    v_exp_f32 v9, v9
    v_mfma_f32_32x32x16_bf16 v[108:123], v[72:75], v[160:163], v[108:123]
    v_exp_f32 v10, v10
    v_exp_f32 v11, v11
    v_exp_f32 v12, v12
    v_exp_f32 v13, v13
    v_mfma_f32_32x32x16_bf16 v[24:39], v[56:59], v[52:55], 0
    buffer_load_dwordx4 v[56:59], v1, s[16:19], s53 offen sc1
    v_exp_f32 v14, v14
    v_exp_f32 v15, v15
    v_cvt_pk_bf16_f32 v156, v8, v9
    v_cvt_pk_bf16_f32 v157, v10, v11
    v_cvt_pk_bf16_f32 v158, v12, v13
    v_cvt_pk_bf16_f32 v159, v14, v15
    v_exp_f32 v16, v16
    v_exp_f32 v17, v17
    v_mfma_f32_32x32x16_bf16 v[124:139], v[68:71], v[156:159], v[124:139]
    v_exp_f32 v18, v18
    v_exp_f32 v19, v19
    v_exp_f32 v20, v20
    v_exp_f32 v21, v21
    v_exp_f32 v22, v22
    v_exp_f32 v23, v23
    v_cvt_pk_bf16_f32 v160, v16, v17
    v_cvt_pk_bf16_f32 v161, v18, v19
    v_cvt_pk_bf16_f32 v162, v20, v21
    v_cvt_pk_bf16_f32 v163, v22, v23
    v_exp_f32 v24, v24
    v_exp_f32 v25, v25
    v_mfma_f32_32x32x16_bf16 v[124:139], v[72:75], v[160:163], v[124:139]
    v_exp_f32 v26, v26
    v_exp_f32 v27, v27
    v_exp_f32 v28, v28
    v_exp_f32 v29, v29
    s_waitcnt vmcnt(4)
    v_mfma_f32_32x32x16_bf16 v[8:23], v[60:63], v[40:43], 0
    s_add_u32 s46, s46, 1
    s_cmp_lt_u32 s46, 6
    v_exp_f32 v30, v30
    v_exp_f32 v31, v31
    v_cvt_pk_bf16_f32 v156, v24, v25
    v_cvt_pk_bf16_f32 v157, v26, v27
    v_cvt_pk_bf16_f32 v158, v28, v29
    v_cvt_pk_bf16_f32 v159, v30, v31
    v_exp_f32 v32, v32
    v_exp_f32 v33, v33
    v_mfma_f32_32x32x16_bf16 v[140:155], v[68:71], v[156:159], v[140:155]
    v_exp_f32 v34, v34
    v_exp_f32 v35, v35
    v_exp_f32 v36, v36
    v_exp_f32 v37, v37
    v_exp_f32 v38, v38
    v_exp_f32 v39, v39
    v_cvt_pk_bf16_f32 v160, v32, v33
    v_cvt_pk_bf16_f32 v161, v34, v35
    v_cvt_pk_bf16_f32 v162, v36, v37
    v_cvt_pk_bf16_f32 v163, v38, v39
    s_cbranch_scc1 KF_AL
    s_setprio 3
    v_mfma_f32_32x32x16_bf16 v[140:155], v[72:75], v[160:163], v[140:155]
    v_and_b32 v2, 0x3ff, v5
    s_lshl_b32 s39, s37, 1
    ds_read_b32 v8, v2 offset:0
    s_mul_i32 s40, s37, 27648
    s_add_u32 s40, s40, 4096
    v_lshrrev_b32 v3, 2, v1
    s_add_u32 s48, s36, 1
    s_and_b32 s48, s48, 3
    s_mul_i32 s48, s48, 6912
    s_add_u32 s48, s48, s40
    v_add_u32 v10, s48, v1
    v_add_u32 v11, s48, v3
    s_add_u32 s48, s36, 2
    s_and_b32 s48, s48, 3
    s_mul_i32 s48, s48, 6912
    s_add_u32 s48, s48, s40
    v_add_u32 v12, s48, v1
    v_add_u32 v13, s48, v3
    s_add_u32 s48, s36, 3
    s_and_b32 s48, s48, 3
    s_mul_i32 s48, s48, 6912
    s_add_u32 s48, s48, s40
    v_add_u32 v14, s48, v1
    v_add_u32 v15, s48, v3
KF_MR:
    s_waitcnt lgkmcnt(0)
    v_cmp_gt_u32 vcc, s39, v8
    s_cbranch_vccnz KF_MR2
    ds_write_b128 v10, v[108:111] offset:0
    ds_write_b128 v10, v[112:115] offset:1024
    ds_write_b32 v11, v116 offset:2048
    ds_write_b128 v12, v[124:127] offset:2304
    ds_write_b128 v12, v[128:131] offset:3328
    ds_write_b32 v13, v132 offset:4352
    ds_write_b128 v14, v[140:143] offset:4608
    ds_write_b128 v14, v[144:147] offset:5632
    ds_write_b32 v15, v148 offset:6656
    s_mul_i32 s48, s36, 6912
    s_add_u32 s48, s48, s40
    v_add_u32 v8, s48, v1
    v_add_u32 v9, s48, v3
    v_mov_b32 v2, 1
    s_lshl_b32 s39, s38, 15
    s_lshl_b32 s42, s58, 10
    s_add_u32 s39, s39, s42
    s_cmp_eq_u32 s96, 0
    s_cselect_b32 s42, 0, 0x0
    s_add_u32 s39, s39, s42
    s_add_u32 s39, s39, 0x1000000
    s_mov_b32 s42, 0x21800000
    s_mov_b32 s43, 0x5d800000
    s_waitcnt lgkmcnt(0)
    ds_write_b32 v4, v2 offset:0
KF_MW:
    ds_read_b32 v3, v5 offset:0
    s_waitcnt lgkmcnt(0)
    v_cmp_gt_i32 vcc, 0, v3
    s_cbranch_vccnz KF_FIN
    v_cmp_eq_u32 vcc, 0, v3
    s_cbranch_vccz KF_MG
    s_sleep 1
    s_branch KF_MW
KF_MG:
    ds_read_b128 v[108:111], v8 offset:0
    ds_read_b128 v[112:115], v8 offset:1024
    ds_read_b32 v116, v9 offset:2048
    ds_read_b128 v[124:127], v8 offset:2304
    ds_read_b128 v[128:131], v8 offset:3328
    ds_read_b32 v132, v9 offset:4352
    ds_read_b128 v[140:143], v8 offset:4608
    ds_read_b128 v[144:147], v8 offset:5632
    ds_read_b32 v148, v9 offset:6656
    v_mov_b32 v2, 0x207
    s_waitcnt lgkmcnt(6)
    v_pk_add_f32 v[92:93], v[92:93], v[108:109]
    v_pk_add_f32 v[94:95], v[94:95], v[110:111]
    v_pk_add_f32 v[96:97], v[96:97], v[112:113]
    v_pk_add_f32 v[98:99], v[98:99], v[114:115]
    v_add_f32 v100, v100, v116
    s_waitcnt lgkmcnt(3)
    v_pk_add_f32 v[92:93], v[92:93], v[124:125]
    v_pk_add_f32 v[94:95], v[94:95], v[126:127]
    v_pk_add_f32 v[96:97], v[96:97], v[128:129]
    v_pk_add_f32 v[98:99], v[98:99], v[130:131]
    v_add_f32 v100, v100, v132
    s_waitcnt lgkmcnt(0)
    v_pk_add_f32 v[92:93], v[92:93], v[140:141]
    v_pk_add_f32 v[94:95], v[94:95], v[142:143]
    v_pk_add_f32 v[96:97], v[96:97], v[144:145]
    v_pk_add_f32 v[98:99], v[98:99], v[146:147]
    v_add_f32 v100, v100, v148
    v_rcp_f32 v3, v100
    v_pk_add_f32 v[10:11], v[92:93], v[94:95]
    v_pk_add_f32 v[12:13], v[96:97], v[98:99]
    v_cmp_nge_f32 s[50:51], v100, s42
    v_pk_add_f32 v[10:11], v[10:11], v[12:13]
    v_cmp_nle_f32 s[52:53], v100, s43
    v_add_f32 v10, v10, v11
    v_mul_f32 v92, v92, v3
    v_cmp_class_f32 vcc, v10, v2
    v_mul_f32 v93, v93, v3
    v_mul_f32 v94, v94, v3
    s_or_b64 s[50:51], s[50:51], s[52:53]
    v_mul_f32 v95, v95, v3
    v_mul_f32 v96, v96, v3
    v_mul_f32 v97, v97, v3
    v_mul_f32 v98, v98, v3
    v_mul_f32 v99, v99, v3
    v_cvt_pk_bf16_f32 v156, v92, v93
    s_or_b64 s[50:51], s[50:51], vcc
    v_cvt_pk_bf16_f32 v157, v94, v95
    v_cvt_pk_bf16_f32 v158, v96, v97
    v_cvt_pk_bf16_f32 v159, v98, v99
    s_cbranch_scc1 KF_EX
KF_NRM:
    buffer_store_dwordx4 v[156:159], v1, s[16:19], s39 offen sc1
    s_load_dwordx2 s[24:25], s[0:1], 64
    s_sub_u32 s40, s96, 1
    s_cmp_lt_u32 s40, 2
    s_cselect_b32 s37, 1, s37
    s_mov_b64 exec, 1
    s_waitcnt vmcnt(0)
    buffer_store_dwordx2 v[6:7], v1, s[16:19], s59 offen sc1
    s_cmp_lg_u32 s37, 0
    s_cbranch_scc1 KF_FIN
    s_mov_b64 exec, -1
    v_and_b32 v164, 63, v0
    v_lshlrev_b32 v1, 4, v164
    s_and_b32 s40, s33, 3
    s_lshl_b32 s41, s32, 2
    s_add_u32 s40, s40, s41
    s_lshl_b32 s40, s40, 1
    s_and_b32 s41, s36, 1
    s_add_u32 s40, s40, s41
    s_lshr_b32 s41, s33, 2
    s_lshl_b32 s41, s41, 1
    s_lshr_b32 s42, s36, 1
    s_add_u32 s41, s41, s42
    s_lshl_b32 s49, s40, 15
    s_cmp_eq_u32 s96, 0
    s_cselect_b32 s47, 0, 0x0
    s_add_u32 s47, s47, s49
    s_add_u32 s47, s47, 0x1000000
    s_lshl_b32 s42, s41, 6
    s_add_u32 s49, s49, s42
    s_lshl_b32 s48, s40, 8
    s_add_u32 s48, s48, 0x1414000
    s_lshl_b32 s50, s40, 9
    s_add_u32 s50, s50, 0x1400000
    s_lshl_b32 s51, s36, 12
    s_add_u32 s51, s51, 98304
    s_lshl_b32 s41, s36, 5
    s_and_b32 s41, s41, 64
    s_mov_b32 s42, 0
    v_add_u32 v3, s51, v1
    v_lshrrev_b32 v160, 5, v164
    v_lshlrev_b32 v160, 4, v160
    v_and_b32 v165, 31, v164
    v_lshl_add_u32 v160, v165, 10, v160
    v_and_b32 v165, 15, v164
    v_lshlrev_b32 v165, 3, v165
    v_add_u32 v162, s48, v165
    v_add_u32 v7, s50, v1
    v_cmp_gt_u32 vcc, 32, v164
    s_nop 1
    v_cndmask_b32 v7, v162, v7, vcc
    v_add_u32 v162, 128, v162
    v_mov_b32 v163, s13
    v_mov_b32 v161, 0
    s_mov_b32 s46, 0
    s_mov_b32 s43, 0
    s_waitcnt lgkmcnt(0)
    s_and_b32 s25, s25, 0xffff
    s_mov_b32 s26, 0x200000
    s_mov_b32 s27, 0x00020000
KF_TG:
    s_memrealtime s[52:53]
    s_add_u32 s43, s43, 1
    s_waitcnt lgkmcnt(0)
    s_sub_u32 s52, s52, s12
    s_cmp_gt_u32 s43, 0x10000
    s_cbranch_scc1 KF_TG2
    s_cmp_lt_u32 s52, 3400
    s_cbranch_scc1 KF_TG
KF_TG2:
    v_bfe_u32 v165, v164, 2, 2
    v_lshrrev_b32 v166, 5, v164
    v_lshl_add_u32 v6, v166, 2, v165
    v_lshlrev_b32 v6, 7, v6
    v_lshrrev_b32 v165, 1, v165
    v_lshl_add_u32 v6, v165, 6, v6
    v_bfe_u32 v165, v164, 4, 1
    v_lshl_add_u32 v6, v165, 5, v6
    v_and_b32 v165, 3, v164
    v_lshl_add_u32 v6, v165, 3, v6
    v_add_u32 v6, s42, v6
    v_xor_b32 v165, 64, v6
    v_xor_b32 v6, s41, v6
    v_mov_b32 v136, 0
    v_mov_b32 v137, 0
    v_mov_b32 v138, 0
    v_mov_b32 v139, 0
    v_mov_b32 v140, 0
    v_mov_b32 v141, 0
    v_mov_b32 v142, 0
    v_mov_b32 v143, 0
    v_mov_b32 v144, 0
    v_mov_b32 v145, 0
    v_mov_b32 v146, 0
    v_mov_b32 v147, 0
    v_mov_b32 v148, 0
    v_mov_b32 v149, 0
    v_mov_b32 v150, 0
    v_mov_b32 v151, 0
KF_OW0:
    ds_read_b32 v164, v5 offset:2080
    s_waitcnt lgkmcnt(0)
    v_cmp_gt_u32 vcc, 17, v164
    s_cbranch_vccz KF_OL
    s_sleep 2
    s_branch KF_OW0
KF_OL:
    ds_read_b64_tr_b16 v[8:9], v6 offset:32768
    ds_read_b64_tr_b16 v[10:11], v6 offset:33792
    ds_read_b64_tr_b16 v[12:13], v6 offset:34816
    ds_read_b64_tr_b16 v[14:15], v6 offset:35840
    ds_read_b64_tr_b16 v[16:17], v6 offset:36864
    ds_read_b64_tr_b16 v[18:19], v6 offset:37888
    ds_read_b64_tr_b16 v[20:21], v6 offset:38912
    ds_read_b64_tr_b16 v[22:23], v6 offset:39936
    ds_read_b64_tr_b16 v[24:25], v6 offset:40960
    ds_read_b64_tr_b16 v[26:27], v6 offset:41984
    ds_read_b64_tr_b16 v[28:29], v6 offset:43008
    ds_read_b64_tr_b16 v[30:31], v6 offset:44032
    ds_read_b64_tr_b16 v[32:33], v6 offset:45056
    ds_read_b64_tr_b16 v[34:35], v6 offset:46080
    ds_read_b64_tr_b16 v[36:37], v6 offset:47104
    ds_read_b64_tr_b16 v[38:39], v6 offset:48128
    ds_read_b64_tr_b16 v[40:41], v6 offset:49152
    ds_read_b64_tr_b16 v[42:43], v6 offset:50176
    ds_read_b64_tr_b16 v[44:45], v6 offset:51200
    ds_read_b64_tr_b16 v[46:47], v6 offset:52224
    ds_read_b64_tr_b16 v[48:49], v6 offset:53248
    ds_read_b64_tr_b16 v[50:51], v6 offset:54272
    ds_read_b64_tr_b16 v[52:53], v6 offset:55296
    ds_read_b64_tr_b16 v[54:55], v6 offset:56320
    ds_read_b64_tr_b16 v[56:57], v6 offset:57344
    ds_read_b64_tr_b16 v[58:59], v6 offset:58368
    ds_read_b64_tr_b16 v[60:61], v6 offset:59392
    ds_read_b64_tr_b16 v[62:63], v6 offset:60416
    ds_read_b64_tr_b16 v[64:65], v6 offset:61440
    ds_read_b64_tr_b16 v[66:67], v6 offset:62464
    ds_read_b64_tr_b16 v[68:69], v6 offset:63488
    ds_read_b64_tr_b16 v[70:71], v6 offset:64512
    v_mov_b32 v164, 2
    ds_max_u32 v4, v164 offset:0
    s_mov_b32 s43, 3000
    s_lshl_b32 s42, s46, 10
    s_add_u32 s42, s42, s47
    s_mov_b32 s50, 0xffff
    s_mov_b32 s51, 0xffff
    s_mov_b32 s53, 0
    s_cmp_eq_u32 s46, 0
    s_cbranch_scc1 KF_OH2
KF_OH:
    s_sleep 2
    ds_read_b32 v164, v5 offset:1040
    s_waitcnt lgkmcnt(0)
    v_cmp_gt_u32 vcc, 1, v164
    s_cbranch_vccnz KF_OH
KF_OH2:
KF_OP:
    buffer_load_dwordx3 v[164:166], v7, s[16:19], 0 offen sc1
    s_waitcnt vmcnt(0)
    v_subrev_co_u32 v164, vcc, s12, v164
    s_nop 1
    v_subb_co_u32 v165, vcc, v165, v163, vcc
    v_lshrrev_b32 v164, 24, v164
    v_or_b32 v164, v164, v165
    v_cmp_ne_u32 vcc, 0, v164
    s_and_b64 vcc, vcc, s[98:99]
    s_cbranch_vccz KF_OG
    s_sub_u32 s43, s43, 1
    s_cmp_lt_i32 s43, 0
    s_cbranch_scc1 KF_OFAIL
    s_sleep 4
    s_branch KF_OP
KF_OW:
    v_mov_b32 v165, v166
    v_mov_b32 v7, v162
    v_add_u32 v6, 98304, v6
    v_permlane32_swap_b32 v166, v165
    v_lshlrev_b32 v161, 16, v166
    v_and_b32 v162, 0xffff0000, v166
    s_mov_b64 vcc, -1
    s_branch KF_OG2
KF_OG:
    s_cmp_eq_u32 s46, 0
    s_cbranch_scc1 KF_OW
KF_OG2:
    s_mov_b32 s53, 1
KF_OG3:
    buffer_load_dwordx4 v[72:75], v1, s[16:19], s42 offen offset:0 sc1
    s_cbranch_vccz KF_NS0
    s_sleep 3
KF_NS0:
    buffer_load_dwordx4 v[76:79], v1, s[16:19], s42 offen offset:2048 sc1
    s_add_u32 s42, s42, 4096
    s_cbranch_vccz KF_NS1
    s_sleep 3
KF_NS1:
    buffer_load_dwordx4 v[80:83], v1, s[16:19], s42 offen offset:0 sc1
    s_cbranch_vccz KF_NS2
    s_sleep 3
KF_NS2:
    buffer_load_dwordx4 v[84:87], v1, s[16:19], s42 offen offset:2048 sc1
    s_add_u32 s42, s42, 4096
    s_cbranch_vccz KF_NS3
    s_sleep 3
KF_NS3:
    buffer_load_dwordx4 v[88:91], v1, s[16:19], s42 offen offset:0 sc1
    s_cbranch_vccz KF_NS4
    s_sleep 3
KF_NS4:
    buffer_load_dwordx4 v[92:95], v1, s[16:19], s42 offen offset:2048 sc1
    s_add_u32 s42, s42, 4096
    s_cbranch_vccz KF_NS5
    s_sleep 3
KF_NS5:
    buffer_load_dwordx4 v[96:99], v1, s[16:19], s42 offen offset:0 sc1
    s_cbranch_vccz KF_NS6
    s_sleep 3
KF_NS6:
    buffer_load_dwordx4 v[100:103], v1, s[16:19], s42 offen offset:2048 sc1
    s_add_u32 s42, s42, 4096
    s_cbranch_vccz KF_NS7
    s_sleep 3
KF_NS7:
    buffer_load_dwordx4 v[104:107], v1, s[16:19], s42 offen offset:0 sc1
    s_cbranch_vccz KF_NS8
    s_sleep 3
KF_NS8:
    buffer_load_dwordx4 v[108:111], v1, s[16:19], s42 offen offset:2048 sc1
    s_add_u32 s42, s42, 4096
    s_cbranch_vccz KF_NS9
    s_sleep 3
KF_NS9:
    buffer_load_dwordx4 v[112:115], v1, s[16:19], s42 offen offset:0 sc1
    s_cbranch_vccz KF_NS10
    s_sleep 3
KF_NS10:
    buffer_load_dwordx4 v[116:119], v1, s[16:19], s42 offen offset:2048 sc1
    s_add_u32 s42, s42, 4096
    s_cbranch_vccz KF_NS11
    s_sleep 3
KF_NS11:
    buffer_load_dwordx4 v[120:123], v1, s[16:19], s42 offen offset:0 sc1
    s_cbranch_vccz KF_NS12
    s_sleep 3
KF_NS12:
    buffer_load_dwordx4 v[124:127], v1, s[16:19], s42 offen offset:2048 sc1
    s_add_u32 s42, s42, 4096
    s_cbranch_vccz KF_NS13
    s_sleep 3
KF_NS13:
    buffer_load_dwordx4 v[128:131], v1, s[16:19], s42 offen offset:0 sc1
    s_cbranch_vccz KF_NS14
    s_sleep 3
KF_NS14:
    buffer_load_dwordx4 v[132:135], v1, s[16:19], s42 offen offset:2048 sc1
    s_lshl_b32 s52, s46, 1
KF_BW:
    ds_read_b32 v164, v4 offset:3072
    s_waitcnt lgkmcnt(0)
    v_cmp_gt_u32 vcc, s52, v164
    s_cbranch_vccz KF_BW2
    s_sleep 1
    s_branch KF_BW
KF_BW2:
    v_cmp_eq_u32 vcc, 3, v164
    s_cbranch_vccnz KF_FIN
    s_cmp_eq_u32 s46, 0
KF_EP1:
    ds_read_b128 v[152:155], v3
KF_EP2:
    ds_read_b128 v[156:159], v3 offset:1024
    s_waitcnt vmcnt(15)
    v_mfma_f32_32x32x16_bf16 v[136:151], v[8:11], v[72:75], v[136:151]
    s_waitcnt vmcnt(14)
    v_mfma_f32_32x32x16_bf16 v[136:151], v[12:15], v[76:79], v[136:151]
    s_waitcnt vmcnt(13)
    v_mfma_f32_32x32x16_bf16 v[136:151], v[16:19], v[80:83], v[136:151]
    s_waitcnt vmcnt(12)
    v_mfma_f32_32x32x16_bf16 v[136:151], v[20:23], v[84:87], v[136:151]
    s_waitcnt vmcnt(11)
    v_mfma_f32_32x32x16_bf16 v[136:151], v[24:27], v[88:91], v[136:151]
    s_waitcnt vmcnt(10)
    v_mfma_f32_32x32x16_bf16 v[136:151], v[28:31], v[92:95], v[136:151]
    s_waitcnt vmcnt(9)
    v_mfma_f32_32x32x16_bf16 v[136:151], v[32:35], v[96:99], v[136:151]
    s_waitcnt lgkmcnt(0)
    s_cbranch_scc1 KF_E6
    v_lshlrev_b32 v8, 16, v152
    v_and_b32 v9, 0xffff0000, v152
    v_mul_f32 v8, v8, v162
    v_mul_f32 v9, v9, v162
KF_E6:
    s_waitcnt vmcnt(8)
    v_mfma_f32_32x32x16_bf16 v[136:151], v[36:39], v[100:103], v[136:151]
    s_cbranch_scc1 KF_E7
    v_lshlrev_b32 v10, 16, v153
    v_and_b32 v11, 0xffff0000, v153
    v_mul_f32 v10, v10, v162
    v_mul_f32 v11, v11, v162
KF_E7:
    s_waitcnt vmcnt(7)
    v_mfma_f32_32x32x16_bf16 v[136:151], v[40:43], v[104:107], v[136:151]
    s_cbranch_scc1 KF_E8
    v_lshlrev_b32 v12, 16, v154
    v_and_b32 v13, 0xffff0000, v154
    v_mul_f32 v12, v12, v162
    v_mul_f32 v13, v13, v162
KF_E8:
    s_waitcnt vmcnt(6)
    v_mfma_f32_32x32x16_bf16 v[136:151], v[44:47], v[108:111], v[136:151]
    s_cbranch_scc1 KF_E9
    v_lshlrev_b32 v14, 16, v155
    v_and_b32 v15, 0xffff0000, v155
    v_mul_f32 v14, v14, v162
    v_mul_f32 v15, v15, v162
KF_E9:
    s_waitcnt vmcnt(5)
    v_mfma_f32_32x32x16_bf16 v[136:151], v[48:51], v[112:115], v[136:151]
    s_cbranch_scc1 KF_E10
    v_lshlrev_b32 v16, 16, v156
    v_and_b32 v17, 0xffff0000, v156
    v_mul_f32 v16, v16, v162
    v_mul_f32 v17, v17, v162
KF_E10:
    s_waitcnt vmcnt(4)
    v_mfma_f32_32x32x16_bf16 v[136:151], v[52:55], v[116:119], v[136:151]
    s_cbranch_scc1 KF_E11
    v_lshlrev_b32 v18, 16, v157
    v_and_b32 v19, 0xffff0000, v157
    v_mul_f32 v18, v18, v162
    v_mul_f32 v19, v19, v162
KF_E11:
    s_waitcnt vmcnt(3)
    v_mfma_f32_32x32x16_bf16 v[136:151], v[56:59], v[120:123], v[136:151]
    s_cbranch_scc1 KF_E12
    v_lshlrev_b32 v20, 16, v158
    v_and_b32 v21, 0xffff0000, v158
    v_mul_f32 v20, v20, v162
    v_mul_f32 v21, v21, v162
KF_E12:
    s_waitcnt vmcnt(2)
    v_mfma_f32_32x32x16_bf16 v[136:151], v[60:63], v[124:127], v[136:151]
    s_cbranch_scc1 KF_E13
    v_lshlrev_b32 v22, 16, v159
    v_and_b32 v23, 0xffff0000, v159
    v_mul_f32 v22, v22, v162
    v_mul_f32 v23, v23, v162
KF_E13:
    s_waitcnt vmcnt(1)
    v_mfma_f32_32x32x16_bf16 v[136:151], v[64:67], v[128:131], v[136:151]
    s_waitcnt vmcnt(0)
    v_mfma_f32_32x32x16_bf16 v[136:151], v[68:71], v[132:135], v[136:151]
    s_cbranch_scc1 KF_H0
    s_nop 10
    v_fmac_f32 v8, v136, v161
    v_fmac_f32 v9, v137, v161
    v_fmac_f32 v10, v138, v161
    v_fmac_f32 v11, v139, v161
    v_fmac_f32 v12, v140, v161
    v_fmac_f32 v13, v141, v161
    v_fmac_f32 v14, v142, v161
    v_fmac_f32 v15, v143, v161
    v_fmac_f32 v16, v144, v161
KF_H0:
    s_cbranch_scc1 KF_H1
    v_fmac_f32 v17, v145, v161
    v_fmac_f32 v18, v146, v161
    v_fmac_f32 v19, v147, v161
    v_fmac_f32 v20, v148, v161
    v_fmac_f32 v21, v149, v161
    v_fmac_f32 v22, v150, v161
    v_fmac_f32 v23, v151, v161
    v_cvt_pk_bf16_f32 v152, v8, v9
    v_cvt_pk_bf16_f32 v153, v10, v11
    v_cvt_pk_bf16_f32 v154, v12, v13
KF_H1:
    s_cbranch_scc1 KF_H2
    v_cvt_pk_bf16_f32 v155, v14, v15
    v_cvt_pk_bf16_f32 v156, v16, v17
    v_cvt_pk_bf16_f32 v157, v18, v19
    v_cvt_pk_bf16_f32 v158, v20, v21
    v_cvt_pk_bf16_f32 v159, v22, v23
    v_permlane32_swap_b32 v152, v154
    v_permlane32_swap_b32 v153, v155
KF_H2:
    s_cbranch_scc1 KF_H3
    v_permlane32_swap_b32 v156, v158
    v_permlane32_swap_b32 v157, v159
    buffer_store_dwordx4 v[152:155], v160, s[24:27], s49 offen
    buffer_store_dwordx4 v[156:159], v160, s[24:27], s49 offen offset:32
KF_H3:
    s_add_u32 s46, s46, 1
    s_cmp_lt_u32 s46, 2
    s_cbranch_scc1 KF_OL
KF_FIN:
    s_mov_b64 exec, -1
    v_lshlrev_b32 v2, 2, v0
    v_mov_b32 v3, 2
    ds_max_u32 v2, v3 offset:0
    v_and_b32 v2, 15, v0
    v_min_u32 v2, 11, v2
    v_mul_u32_u24 v2, 0x104, v2
    s_waitcnt lgkmcnt(0)
    s_barrier
    ds_read_b32 v3, v2 offset:0
    s_waitcnt lgkmcnt(0)
    v_cmp_le_u32 vcc, 0x1000, v3
    s_or_b32 s40, vcc_lo, s96
    s_cmp_lg_u32 s40, 0
    s_cbranch_scc1 KF_DISP
    s_endpgm
KF_QEPI:
    s_add_u32 s48, s61, 0x10000
    s_nop 7
    s_nop 1
    v_pk_mul_f32 v[24:25], v[24:25], s[44:45]
    v_pk_mul_f32 v[26:27], v[26:27], s[44:45]
    v_pk_mul_f32 v[28:29], v[28:29], s[44:45]
    v_pk_mul_f32 v[30:31], v[30:31], s[44:45]
    v_pk_mul_f32 v[32:33], v[32:33], s[44:45]
    v_pk_mul_f32 v[34:35], v[34:35], s[44:45]
    v_pk_mul_f32 v[36:37], v[36:37], s[44:45]
    v_pk_mul_f32 v[38:39], v[38:39], s[44:45]
    v_cvt_pk_bf16_f32 v24, v24, v25
    v_cvt_pk_bf16_f32 v25, v26, v27
    v_cvt_pk_bf16_f32 v26, v28, v29
    v_cvt_pk_bf16_f32 v27, v30, v31
    v_cvt_pk_bf16_f32 v28, v32, v33
    v_cvt_pk_bf16_f32 v29, v34, v35
    v_cvt_pk_bf16_f32 v30, v36, v37
    v_cvt_pk_bf16_f32 v31, v38, v39
    buffer_store_dwordx4 v[24:27], v1, s[16:19], s61 offen sc1
    buffer_store_dwordx4 v[28:31], v1, s[16:19], s48 offen sc1
    s_branch KF_TE
KF_SLOW:
    v_and_b32 v8, 0x3ff, v4
    ds_read_b32 v8, v8 offset:3072
    s_waitcnt lgkmcnt(0)
    v_cmp_ne_u32 vcc, 0, v8
    s_cbranch_vccz KF_SLOW2
    s_cmp_eq_u32 s96, 1
    s_cselect_b32 s40, 0, 400
    s_lshl_b32 s48, s34, 10
    s_lshl_b32 s53, s36, 8
    s_add_u32 s48, s48, s53
    s_add_u32 s48, s48, 0x1410000
    s_lshl_b32 s53, s34, 4
    s_add_u32 s53, s53, s35
    s_lshl_b32 s53, s53, 5
    s_add_u32 s53, s53, 0x141c000
    v_lshrrev_b32 v11, 1, v1
    v_and_b32 v10, 24, v11
    v_add_u32 v11, s48, v11
    v_add_u32 v10, s53, v10
    v_cmp_gt_u32 vcc, 0x200, v1
    s_nop 1
    v_cndmask_b32 v11, v10, v11, vcc
    v_mov_b32 v10, s13
KF_SLOW1:
    s_cmp_eq_u32 s40, 0
    s_cbranch_scc1 KF_GO2
    s_sub_u32 s40, s40, 1
    s_sleep 2
    buffer_load_dwordx2 v[8:9], v11, s[16:19], 0 offen sc1
    s_waitcnt vmcnt(0)
    v_subrev_co_u32 v8, vcc, s12, v8
    s_nop 1
    v_subb_co_u32 v9, vcc, v9, v10, vcc
    v_lshrrev_b32 v8, 24, v8
    v_or_b32 v8, v8, v9
    v_cmp_ne_u32 vcc, 0, v8
    s_and_b64 vcc, vcc, s[98:99]
    s_cbranch_vccnz KF_SLOW1
KF_SLOW2:
    s_mov_b64 s[62:63], 0
    s_add_u32 s48, s36, 0
    s_and_b32 s48, s48, 3
    s_lshl_b32 s48, s48, 10
    s_add_u32 s48, s48, s61
    buffer_load_dwordx4 v[40:43], v1, s[16:19], s48 offen sc1
    s_add_u32 s53, s50, s24
    buffer_load_dwordx4 v[56:59], v1, s[16:19], s53 offen sc1
    s_add_u32 s48, s51, s24
    s_mov_b64 exec, s[44:45]
    buffer_load_dwordx4 v[68:71], v1, s[16:19], s48 offen offset:0 sc1
    s_mov_b64 exec, -1
    s_add_u32 s48, s51, s24
    s_mov_b64 exec, s[44:45]
    buffer_load_dwordx4 v[72:75], v1, s[16:19], s48 offen offset:256 sc1
    s_mov_b64 exec, -1
    s_add_u32 s48, s36, 1
    s_and_b32 s48, s48, 3
    s_lshl_b32 s48, s48, 10
    s_add_u32 s48, s48, s61
    buffer_load_dwordx4 v[44:47], v1, s[16:19], s48 offen sc1
    s_add_u32 s48, s36, 2
    s_and_b32 s48, s48, 3
    s_lshl_b32 s48, s48, 10
    s_add_u32 s48, s48, s61
    buffer_load_dwordx4 v[48:51], v1, s[16:19], s48 offen sc1
    s_add_u32 s48, s36, 3
    s_and_b32 s48, s48, 3
    s_lshl_b32 s48, s48, 10
    s_add_u32 s48, s48, s61
    buffer_load_dwordx4 v[52:55], v1, s[16:19], s48 offen sc1
    s_add_u32 s53, s50, s25
    buffer_load_dwordx4 v[60:63], v1, s[16:19], s53 offen sc1
    s_add_u32 s48, s51, s25
    s_mov_b64 exec, s[44:45]
    buffer_load_dwordx4 v[76:79], v1, s[16:19], s48 offen offset:0 sc1
    s_mov_b64 exec, -1
    s_add_u32 s48, s51, s25
    s_mov_b64 exec, s[44:45]
    buffer_load_dwordx4 v[80:83], v1, s[16:19], s48 offen offset:256 sc1
    s_mov_b64 exec, -1
    s_add_u32 s53, s50, s52
    buffer_load_dwordx4 v[64:67], v1, s[16:19], s53 offen sc1
    s_branch KF_GO
KF_LAST:
KF_MR2:
    s_sleep 2
    ds_read_b32 v8, v2 offset:0
    s_branch KF_MR
KF_OFAIL:
    v_mov_b32 v2, -1
    ds_write_b32 v4, v2 offset:0
    s_branch KF_FIN
KF_DISP:
    s_cmp_eq_u32 s96, 3
    s_cbranch_scc1 KF_END
    s_waitcnt vmcnt(0)
    s_barrier
    s_cmp_eq_u32 s96, 0
    s_cselect_b32 s2, 255, s2
    s_add_u32 s2, s2, 1
    s_cmp_lt_u32 s2, 256
    s_cbranch_scc1 KF_D2
    s_add_u32 s96, s96, 1
    s_cmp_eq_u32 s96, 3
    s_cselect_b32 s2, s97, 0
    s_cmp_ge_u32 s96, 2
    s_cselect_b64 s[98:99], 0, -1
KF_D2:
    s_load_dwordx4 s[4:7], s[0:1], 0
    s_load_dwordx2 s[14:15], s[0:1], 80
    s_load_dwordx8 s[88:95], s[0:1], 32
    s_mov_b64 s[56:57], s[100:101]
    s_setprio 0
    s_branch KF_RE
KF_EX:
    s_lshl_b32 s50, s58, 16
    s_add_u32 s51, s50, 0x200000
    s_mov_b32 s46, 0
    v_mov_b32 v2, 0xff800000
    s_waitcnt vmcnt(0)
KF_EX1:
    buffer_load_dwordx4 v[60:63], v1, s[16:19], s51 offen sc1
    s_add_u32 s51, s51, 1024
    s_waitcnt vmcnt(0)
    v_mfma_f32_32x32x16_bf16 v[8:23], v[60:63], v[40:43], 0
    s_nop 11
    v_max3_f32 v2, v8, v9, v2
    v_max3_f32 v2, v10, v11, v2
    v_max3_f32 v2, v12, v13, v2
    v_max3_f32 v2, v14, v15, v2
    v_max3_f32 v2, v16, v17, v2
    v_max3_f32 v2, v18, v19, v2
    v_max3_f32 v2, v20, v21, v2
    v_max3_f32 v2, v22, v23, v2
    s_add_u32 s46, s46, 1
    s_cmp_lt_u32 s46, 64
    s_cbranch_scc1 KF_EX1
    v_mov_b32 v3, v2
    s_nop 1
    v_permlane32_swap_b32 v2, v3
    s_nop 1
    v_max_f32 v2, v2, v3
    v_mul_f32 v24, -1.0, v2
    v_mul_f32 v25, -1.0, v2
    v_mul_f32 v26, -1.0, v2
    v_mul_f32 v27, -1.0, v2
    v_mul_f32 v28, -1.0, v2
    v_mul_f32 v29, -1.0, v2
    v_mul_f32 v30, -1.0, v2
    v_mul_f32 v31, -1.0, v2
    v_mul_f32 v32, -1.0, v2
    v_mul_f32 v33, -1.0, v2
    v_mul_f32 v34, -1.0, v2
    v_mul_f32 v35, -1.0, v2
    v_mul_f32 v36, -1.0, v2
    v_mul_f32 v37, -1.0, v2
    v_mul_f32 v38, -1.0, v2
    v_mul_f32 v39, -1.0, v2
    v_mov_b32 v92, 0
    v_mov_b32 v93, 0
    v_mov_b32 v94, 0
    v_mov_b32 v95, 0
    v_mov_b32 v96, 0
    v_mov_b32 v97, 0
    v_mov_b32 v98, 0
    v_mov_b32 v99, 0
    v_mov_b32 v100, 0
    v_mov_b32 v101, 0
    v_mov_b32 v102, 0
    v_mov_b32 v103, 0
    v_mov_b32 v104, 0
    v_mov_b32 v105, 0
    v_mov_b32 v106, 0
    v_mov_b32 v107, 0
    s_add_u32 s51, s50, 0x200000
    s_add_u32 s50, s50, 0x400000
    s_mov_b32 s46, 0
KF_EX2:
    buffer_load_dwordx4 v[60:63], v1, s[16:19], s51 offen sc1
    s_mov_b64 exec, s[44:45]
    buffer_load_dwordx4 v[76:79], v1, s[16:19], s50 offen sc1
    buffer_load_dwordx4 v[80:83], v1, s[16:19], s50 offen offset:256 sc1
    s_mov_b64 exec, -1
    s_add_u32 s51, s51, 1024
    s_add_u32 s50, s50, 1024
    s_waitcnt vmcnt(0)
    v_mfma_f32_32x32x16_bf16 v[8:23], v[60:63], v[40:43], v[24:39]
    s_nop 11
    v_exp_f32 v8, v8
    v_exp_f32 v9, v9
    v_exp_f32 v10, v10
    v_exp_f32 v11, v11
    v_exp_f32 v12, v12
    v_exp_f32 v13, v13
    v_exp_f32 v14, v14
    v_exp_f32 v15, v15
    v_exp_f32 v16, v16
    v_exp_f32 v17, v17
    v_exp_f32 v18, v18
    v_exp_f32 v19, v19
    v_exp_f32 v20, v20
    v_exp_f32 v21, v21
    v_exp_f32 v22, v22
    v_exp_f32 v23, v23
    v_cvt_pk_bf16_f32 v156, v8, v9
    v_cvt_pk_bf16_f32 v157, v10, v11
    v_cvt_pk_bf16_f32 v158, v12, v13
    v_cvt_pk_bf16_f32 v159, v14, v15
    v_cvt_pk_bf16_f32 v160, v16, v17
    v_cvt_pk_bf16_f32 v161, v18, v19
    v_cvt_pk_bf16_f32 v162, v20, v21
    v_cvt_pk_bf16_f32 v163, v22, v23
    v_mfma_f32_32x32x16_bf16 v[92:107], v[76:79], v[156:159], v[92:107]
    s_nop 0
    v_mfma_f32_32x32x16_bf16 v[92:107], v[80:83], v[160:163], v[92:107]
    s_add_u32 s46, s46, 1
    s_cmp_lt_u32 s46, 64
    s_nop 7
    s_nop 7
    s_cbranch_scc1 KF_EX2
    s_nop 7
    s_nop 7
    v_rcp_f32 v2, v100
    s_nop 0
    v_mul_f32 v92, v92, v2
    v_mul_f32 v93, v93, v2
    v_mul_f32 v94, v94, v2
    v_mul_f32 v95, v95, v2
    v_mul_f32 v96, v96, v2
    v_mul_f32 v97, v97, v2
    v_mul_f32 v98, v98, v2
    v_mul_f32 v99, v99, v2
    v_cvt_pk_bf16_f32 v156, v92, v93
    v_cvt_pk_bf16_f32 v157, v94, v95
    v_cvt_pk_bf16_f32 v158, v96, v97
    v_cvt_pk_bf16_f32 v159, v98, v99
    s_branch KF_NRM
.section .rodata,"a"
.p2align 6
.amdhsa_kernel kf_kernel
  .amdhsa_next_free_vgpr 168
  .amdhsa_next_free_sgpr 102
  .amdhsa_accum_offset 168
  .amdhsa_group_segment_fixed_size 0
  .amdhsa_kernarg_size 88
  .amdhsa_user_sgpr_count 2
  .amdhsa_user_sgpr_kernarg_segment_ptr 1
  .amdhsa_system_sgpr_workgroup_id_x 1
.end_amdhsa_kernel
```
